```python
import torch

def _softmax(x, axis=-1):
    return torch.softmax(x, dim=axis)
def _gelu(x):
    return torch.nn.functional.gelu(x, approximate="tanh")
def _silu(x):
    return torch.nn.functional.silu(x)
def _sigmoid(x):
    return torch.sigmoid(x)
def _layernorm(x, axis=-1, eps=1e-5):
    m = x.mean(dim=axis, keepdim=True)
    v = x.var(dim=axis, keepdim=True, unbiased=False)
    return (x - m) / torch.sqrt(v + eps)
def _scatter_add(tgt, idx, src, axis=0):
    return tgt.clone().index_add_(axis, idx, src)
def _segment_sum(src, seg, n):
    out = torch.zeros((n,) + src.shape[1:], dtype=src.dtype)
    return out.index_add_(0, seg, src)
def _pad(x, pw):
    flat = tuple(v for pair in reversed(pw) for v in pair)
    return torch.nn.functional.pad(x, flat)

kernel_name = 'gather_scatter__molecular_angular_gemnet__graph'

def setup_inputs():

    _w = (lambda a: (lambda t: t.to(torch.bfloat16) if t.is_floating_point() else t)(torch.as_tensor(a)))
    N, deg, De, L = 10000, 16, 4, 3
    E = N * deg
    T = E * deg
    NR = 8
    dist = torch.rand(E).to(float)
    angle = (torch.rand(T) * torch.pi).to(float)
    centers = torch.linspace(0.0, 1.0, NR).to(float)
    ang_freq = torch.arange(1, L + 1).to(float)
    return {
        "m": _w((lambda *s: torch.randn(*s, dtype=torch.bfloat16) * 0.05)(E, De)),
        "idx_in": _w((lambda lo, hi, *s: torch.randint(lo, hi, s))(0, E, T).to(torch.int64)),
        "idx_out": _w((lambda lo, hi, *s: torch.randint(lo, hi, s))(0, E, T).to(torch.int64)),
        "dist": _w(dist),
        "angle": _w(angle),
        "centers": _w(centers),
        "ang_freq": _w(ang_freq),
        "w_rbf": _w((lambda *s: torch.randn(*s, dtype=torch.bfloat16) * 0.2)(NR, De)),
        "w_sbf": _w((lambda *s: torch.randn(*s, dtype=torch.bfloat16) * 0.2)(NR * L, De)),
        "w_down": _w((lambda *s: torch.randn(*s, dtype=torch.bfloat16) * 0.2)(De, De)),
        "w_up": _w((lambda *s: torch.randn(*s, dtype=torch.bfloat16) * 0.2)(De, De)),
    }

def reference(m, idx_in, idx_out, dist, angle, centers, ang_freq, w_rbf, w_sbf, w_down, w_up):
    E, De = m.shape[0], m.shape[1]
    NR = centers.shape[0]
    L = ang_freq.shape[0]
    rbf = torch.exp(-10.0 * (dist[:, None] - centers[None, :]) ** 2)
    cbf = torch.cos(ang_freq[None, :] * angle[:, None])
    rbf_t = rbf[idx_out]
    sbf = torch.reshape(rbf_t[:, :, None] * cbf[:, None, :], (-1, NR * L))
    x = (m[idx_in] @ w_down) * (sbf @ w_sbf)
    agg = _segment_sum(x, idx_out, E)
    return m + (agg @ w_up) * (rbf @ w_rbf)
```

```asm
; @launch kernel=gs_bin_kernel grid=(256,1,1) block=(1024,1,1) lds=151680
; @launch kernel=gather_scatter__molecular_angular_gemnet__graph_kernel grid=(256,1,1) block=(1024,1,1) lds=163408
.amdgcn_target "amdgcn-amd-amdhsa--gfx950"
.text
.globl gs_bin_kernel
.globl gather_scatter__molecular_angular_gemnet__graph_kernel
.p2align 8
.type gs_bin_kernel,@function
gs_bin_kernel:
    s_cmp_ge_u32 s2, 256
    s_cbranch_scc1 gs_bin_kernel_end
    s_load_dwordx2 s[4:5], s[0:1], 16
    s_load_dwordx2 s[8:9], s[0:1], 8
    s_load_dwordx2 s[12:13], s[0:1], 32
    s_load_dwordx2 s[16:17], s[0:1], 104
    v_lshlrev_b32 v1, 4, v0
    v_lshlrev_b32 v2, 3, v0
    v_lshlrev_b32 v3, 2, v0
    v_mov_b32 v4, 1
    v_mov_b32 v5, 0
    v_and_b32 v6, 0x3fc, v3
    ds_write_b32 v6, v5 offset:0
    s_and_b32 s3, s2, 7
    s_lshl_b32 s3, s3, 5
    s_lshr_b32 s22, s2, 3
    s_add_u32 s3, s3, s22
    v_add_u32 v84, 16384, v1
    v_add_u32 v85, 32768, v2
    v_add_u32 v86, 8192, v2
    v_add_u32 v87, 16384, v3
    v_lshrrev_b32 v78, 6, v0
    s_mul_i32 s22, s3, 40000
    s_mul_i32 s23, s3, 20000
    s_movk_i32 s21, 0xfd8f
    v_readfirstlane_b32 s20, v78
    s_waitcnt lgkmcnt(0)
    s_add_u32 s4, s4, s22
    s_addc_u32 s5, s5, 0
    s_sub_u32 s6, 10240000, s22
    s_mov_b32 s7, 0x20000
    s_add_u32 s8, s8, s22
    s_addc_u32 s9, s9, 0
    s_sub_u32 s10, 10240000, s22
    s_mov_b32 s11, 0x20000
    s_add_u32 s12, s12, s23
    s_addc_u32 s13, s13, 0
    s_sub_u32 s14, 5120000, s23
    s_mov_b32 s15, 0x20000
    s_mov_b32 s18, 37257216
    s_mov_b32 s19, 0x20000
    buffer_load_dwordx4 v[8:11], v1, s[4:7], 0 offen
    buffer_load_dwordx4 v[12:15], v84, s[4:7], 0 offen
    buffer_load_dwordx2 v[16:17], v85, s[4:7], 0 offen
    v_lshrrev_b32 v76, 3, v0
    v_and_b32 v77, 7, v0
    v_mul_u32_u24 v88, 264, v76
    v_lshl_add_u32 v88, v77, 5, v88
    v_add_u32 v88, 4096, v88
    v_add_u32 v98, 33792, v88
    v_lshlrev_b32 v89, 8, v76
    v_lshl_add_u32 v89, v77, 4, v89
    v_lshlrev_b32 v90, 2, v76
    v_add_u32 v90, 2048, v90
    v_and_b32 v91, 1, v0
    v_lshlrev_b32 v91, 4, v91
    v_xor_b32 v91, 16, v91
    s_mov_b32 s31, 0xffff
    s_barrier
    buffer_load_dwordx4 v[18:21], v1, s[8:11], 0 offen
    buffer_load_dwordx2 v[28:29], v2, s[12:15], 0 offen
    s_waitcnt vmcnt(4)
    v_mul_hi_u32_u24 v76, 0x68db8c, v8
    v_lshlrev_b32 v36, 2, v76
    v_mad_i32_i24 v8, v76, s21, v8
    ds_add_rtn_u32 v46, v36, v4 offset:0
    v_mul_u32_u24 v56, 264, v76
    v_mul_hi_u32_u24 v77, 0x68db8c, v9
    v_lshlrev_b32 v37, 2, v77
    v_mad_i32_i24 v9, v77, s21, v9
    ds_add_rtn_u32 v47, v37, v4 offset:0
    v_mul_u32_u24 v57, 264, v77
    v_mul_hi_u32_u24 v78, 0x68db8c, v10
    v_lshlrev_b32 v38, 2, v78
    v_mad_i32_i24 v10, v78, s21, v10
    ds_add_rtn_u32 v48, v38, v4 offset:0
    v_mul_u32_u24 v58, 264, v78
    v_mul_hi_u32_u24 v79, 0x68db8c, v11
    v_lshlrev_b32 v39, 2, v79
    v_mad_i32_i24 v11, v79, s21, v11
    ds_add_rtn_u32 v49, v39, v4 offset:0
    v_mul_u32_u24 v59, 264, v79
    s_waitcnt vmcnt(3)
    v_mul_hi_u32_u24 v76, 0x68db8c, v12
    v_lshlrev_b32 v40, 2, v76
    v_mad_i32_i24 v12, v76, s21, v12
    ds_add_rtn_u32 v50, v40, v4 offset:0
    v_mul_u32_u24 v60, 264, v76
    v_mul_hi_u32_u24 v77, 0x68db8c, v13
    v_lshlrev_b32 v41, 2, v77
    v_mad_i32_i24 v13, v77, s21, v13
    ds_add_rtn_u32 v51, v41, v4 offset:0
    v_mul_u32_u24 v61, 264, v77
    v_mul_hi_u32_u24 v78, 0x68db8c, v14
    v_lshlrev_b32 v42, 2, v78
    v_mad_i32_i24 v14, v78, s21, v14
    ds_add_rtn_u32 v52, v42, v4 offset:0
    v_mul_u32_u24 v62, 264, v78
    v_mul_hi_u32_u24 v79, 0x68db8c, v15
    v_lshlrev_b32 v43, 2, v79
    v_mad_i32_i24 v15, v79, s21, v15
    ds_add_rtn_u32 v53, v43, v4 offset:0
    v_mul_u32_u24 v63, 264, v79
    v_cmp_gt_u32 vcc, 0x388, v0
    s_waitcnt vmcnt(2)
    s_mov_b64 s[100:101], vcc
    s_mov_b64 exec, vcc
    v_mul_hi_u32_u24 v76, 0x68db8c, v16
    v_lshlrev_b32 v44, 2, v76
    v_mad_i32_i24 v16, v76, s21, v16
    ds_add_rtn_u32 v54, v44, v4 offset:0
    v_mul_u32_u24 v64, 264, v76
    v_mul_hi_u32_u24 v77, 0x68db8c, v17
    v_lshlrev_b32 v45, 2, v77
    v_mad_i32_i24 v17, v77, s21, v17
    ds_add_rtn_u32 v55, v45, v4 offset:0
    v_mul_u32_u24 v65, 264, v77
    s_mov_b64 exec, -1
    s_waitcnt lgkmcnt(0)
    s_barrier
    buffer_load_dwordx4 v[22:25], v84, s[8:11], 0 offen
    buffer_load_dwordx2 v[30:31], v86, s[12:15], 0 offen
    buffer_load_dwordx2 v[26:27], v85, s[8:11], 0 offen
    buffer_load_dword v32, v87, s[12:15], 0 offen
    v_and_b32 v6, 63, v0
    v_lshlrev_b32 v6, 4, v6
    ds_read_b128 v[80:83], v6 offset:0
    v_cmp_gt_u32_e64 s[32:33], 40, v46
    v_and_b32 v76, 7, v46
    v_lshl_add_u32 v56, v76, 5, v56
    v_lshrrev_b32 v76, 3, v46
    v_lshl_add_u32 v66, v76, 1, v56
    v_lshl_add_u32 v56, v76, 2, v56
    v_cmp_gt_u32_e64 s[34:35], 40, v47
    v_and_b32 v77, 7, v47
    v_lshl_add_u32 v57, v77, 5, v57
    v_lshrrev_b32 v77, 3, v47
    v_lshl_add_u32 v67, v77, 1, v57
    v_lshl_add_u32 v57, v77, 2, v57
    v_cmp_gt_u32_e64 s[36:37], 40, v48
    v_and_b32 v78, 7, v48
    v_lshl_add_u32 v58, v78, 5, v58
    v_lshrrev_b32 v78, 3, v48
    v_lshl_add_u32 v68, v78, 1, v58
    v_lshl_add_u32 v58, v78, 2, v58
    v_cmp_gt_u32_e64 s[38:39], 40, v49
    v_and_b32 v79, 7, v49
    v_lshl_add_u32 v59, v79, 5, v59
    v_lshrrev_b32 v79, 3, v49
    v_lshl_add_u32 v69, v79, 1, v59
    v_lshl_add_u32 v59, v79, 2, v59
    v_cmp_gt_u32_e64 s[40:41], 40, v50
    v_and_b32 v76, 7, v50
    v_lshl_add_u32 v60, v76, 5, v60
    v_lshrrev_b32 v76, 3, v50
    v_lshl_add_u32 v70, v76, 1, v60
    v_lshl_add_u32 v60, v76, 2, v60
    v_cmp_gt_u32_e64 s[42:43], 40, v51
    v_and_b32 v77, 7, v51
    v_lshl_add_u32 v61, v77, 5, v61
    v_lshrrev_b32 v77, 3, v51
    v_lshl_add_u32 v71, v77, 1, v61
    v_lshl_add_u32 v61, v77, 2, v61
    v_cmp_gt_u32_e64 s[44:45], 40, v52
    v_and_b32 v78, 7, v52
    v_lshl_add_u32 v62, v78, 5, v62
    v_lshrrev_b32 v78, 3, v52
    v_lshl_add_u32 v72, v78, 1, v62
    v_lshl_add_u32 v62, v78, 2, v62
    v_cmp_gt_u32_e64 s[46:47], 40, v53
    v_and_b32 v79, 7, v53
    v_lshl_add_u32 v63, v79, 5, v63
    v_lshrrev_b32 v79, 3, v53
    v_lshl_add_u32 v73, v79, 1, v63
    v_lshl_add_u32 v63, v79, 2, v63
    v_cmp_gt_u32_e64 s[48:49], 40, v54
    v_and_b32 v76, 7, v54
    v_lshl_add_u32 v64, v76, 5, v64
    v_lshrrev_b32 v76, 3, v54
    v_lshl_add_u32 v74, v76, 1, v64
    v_lshl_add_u32 v64, v76, 2, v64
    v_cmp_gt_u32_e64 s[50:51], 40, v55
    v_and_b32 v77, 7, v55
    v_lshl_add_u32 v65, v77, 5, v65
    v_lshrrev_b32 v77, 3, v55
    v_lshl_add_u32 v75, v77, 1, v65
    v_lshl_add_u32 v65, v77, 2, v65
    s_waitcnt lgkmcnt(0)
    v_subrev_u32 v100, 40, v80
    v_subrev_u32 v101, 40, v81
    v_subrev_u32 v102, 40, v82
    v_subrev_u32 v103, 40, v83
    v_max_i32 v100, 0, v100
    v_max_i32 v101, 0, v101
    v_max_i32 v102, 0, v102
    v_max_i32 v103, 0, v103
    v_add_u32 v94, v100, v101
    v_add_u32 v95, v94, v102
    v_add_u32 v96, v95, v103
    v_mov_b32 v97, v96
    s_nop 1
    v_add_u32_dpp v97, v97, v97 row_shr:1 row_mask:0xf bank_mask:0xf bound_ctrl:0
    s_nop 1
    v_add_u32_dpp v97, v97, v97 row_shr:2 row_mask:0xf bank_mask:0xf bound_ctrl:0
    s_nop 1
    v_add_u32_dpp v97, v97, v97 row_shr:4 row_mask:0xf bank_mask:0xf bound_ctrl:0
    s_nop 1
    v_add_u32_dpp v97, v97, v97 row_shr:8 row_mask:0xf bank_mask:0xf bound_ctrl:0
    s_nop 1
    v_add_u32_dpp v97, v97, v97 row_bcast:15 row_mask:0xa bank_mask:0xf
    s_nop 1
    v_add_u32_dpp v97, v97, v97 row_bcast:31 row_mask:0xc bank_mask:0xf
    v_sub_u32 v92, v97, v96
    v_readlane_b32 s23, v97, 63
    v_add_u32 v93, v92, v100
    v_add_u32 v94, v92, v94
    v_add_u32 v95, v92, v95
    v_lshl_or_b32 v80, v80, 16, v92
    v_lshl_or_b32 v81, v81, 16, v93
    v_lshl_or_b32 v82, v82, 16, v94
    v_lshl_or_b32 v83, v83, 16, v95
    s_mov_b32 s22, 67264
    v_lshl_add_u32 v92, v92, 3, s22
    v_lshl_add_u32 v93, v93, 3, s22
    v_lshl_add_u32 v94, v94, 3, s22
    v_lshl_add_u32 v95, v95, 3, s22
    ds_write_b128 v6, v[92:95] offset:1024
    ds_write_b128 v6, v[80:83] offset:2048
    s_andn2_b64 exec, -1, s[32:33]
    ds_read_b32 v36, v36 offset:1024
    s_andn2_b64 exec, -1, s[34:35]
    ds_read_b32 v37, v37 offset:1024
    s_andn2_b64 exec, -1, s[36:37]
    ds_read_b32 v38, v38 offset:1024
    s_andn2_b64 exec, -1, s[38:39]
    ds_read_b32 v39, v39 offset:1024
    s_andn2_b64 exec, -1, s[40:41]
    ds_read_b32 v40, v40 offset:1024
    s_andn2_b64 exec, -1, s[42:43]
    ds_read_b32 v41, v41 offset:1024
    s_andn2_b64 exec, -1, s[44:45]
    ds_read_b32 v42, v42 offset:1024
    s_andn2_b64 exec, -1, s[46:47]
    ds_read_b32 v43, v43 offset:1024
    s_andn2_b64 exec, s[100:101], s[48:49]
    ds_read_b32 v44, v44 offset:1024
    s_andn2_b64 exec, s[100:101], s[50:51]
    ds_read_b32 v45, v45 offset:1024
    s_waitcnt lgkmcnt(0)
    s_andn2_b64 exec, -1, s[32:33]
    v_lshl_add_u32 v56, v46, 3, v36
    v_add_u32 v66, -16, v56
    s_andn2_b64 exec, -1, s[34:35]
    v_lshl_add_u32 v57, v47, 3, v37
    v_add_u32 v67, -16, v57
    s_andn2_b64 exec, -1, s[36:37]
    v_lshl_add_u32 v58, v48, 3, v38
    v_add_u32 v68, -16, v58
    s_andn2_b64 exec, -1, s[38:39]
    v_lshl_add_u32 v59, v49, 3, v39
    v_add_u32 v69, -16, v59
    s_andn2_b64 exec, -1, s[40:41]
    v_lshl_add_u32 v60, v50, 3, v40
    v_add_u32 v70, -16, v60
    s_andn2_b64 exec, -1, s[42:43]
    v_lshl_add_u32 v61, v51, 3, v41
    v_add_u32 v71, -16, v61
    s_andn2_b64 exec, -1, s[44:45]
    v_lshl_add_u32 v62, v52, 3, v42
    v_add_u32 v72, -16, v62
    s_andn2_b64 exec, -1, s[46:47]
    v_lshl_add_u32 v63, v53, 3, v43
    v_add_u32 v73, -16, v63
    s_andn2_b64 exec, s[100:101], s[48:49]
    v_lshl_add_u32 v64, v54, 3, v44
    v_add_u32 v74, -16, v64
    s_andn2_b64 exec, s[100:101], s[50:51]
    v_lshl_add_u32 v65, v55, 3, v45
    v_add_u32 v75, -16, v65
    s_mov_b64 exec, -1
    s_waitcnt vmcnt(5)
    v_lshl_or_b32 v18, v18, 13, v8
    ds_write_b32 v56, v18 offset:4096
    v_lshl_or_b32 v19, v19, 13, v9
    ds_write_b32 v57, v19 offset:4096
    v_lshl_or_b32 v20, v20, 13, v10
    ds_write_b32 v58, v20 offset:4096
    v_lshl_or_b32 v21, v21, 13, v11
    ds_write_b32 v59, v21 offset:4096
    s_waitcnt vmcnt(4)
    ds_write_b16 v66, v28 offset:4116
    ds_write_b16_d16_hi v67, v28 offset:4116
    ds_write_b16 v68, v29 offset:4116
    ds_write_b16_d16_hi v69, v29 offset:4116
    s_waitcnt vmcnt(3)
    v_lshl_or_b32 v22, v22, 13, v12
    ds_write_b32 v60, v22 offset:4096
    v_lshl_or_b32 v23, v23, 13, v13
    ds_write_b32 v61, v23 offset:4096
    v_lshl_or_b32 v24, v24, 13, v14
    ds_write_b32 v62, v24 offset:4096
    v_lshl_or_b32 v25, v25, 13, v15
    ds_write_b32 v63, v25 offset:4096
    s_waitcnt vmcnt(2)
    ds_write_b16 v70, v30 offset:4116
    ds_write_b16_d16_hi v71, v30 offset:4116
    ds_write_b16 v72, v31 offset:4116
    ds_write_b16_d16_hi v73, v31 offset:4116
    s_waitcnt vmcnt(1)
    s_mov_b64 exec, s[100:101]
    v_lshl_or_b32 v26, v26, 13, v16
    ds_write_b32 v64, v26 offset:4096
    v_lshl_or_b32 v27, v27, 13, v17
    ds_write_b32 v65, v27 offset:4096
    s_waitcnt vmcnt(0)
    ds_write_b16 v74, v32 offset:4116
    ds_write_b16_d16_hi v75, v32 offset:4116
    s_mov_b64 exec, -1
    v_add_u32 v78, 71680, v1
    s_lshl_b32 s24, s3, 16
    s_add_u32 s26, s24, 32768
    s_mul_i32 s27, s3, 80000
    s_add_u32 s27, s27, 0x1000000
    s_lshl_b32 s29, s23, 3
    s_waitcnt lgkmcnt(0)
    s_barrier
    ds_read2_b64 v[8:11], v88 offset0:0 offset1:1
    ds_read2_b64 v[12:15], v98 offset0:0 offset1:1
    ds_read2_b32 v[28:29], v90 offset0:0 offset1:128
    ds_read2_b64 v[16:19], v88 offset0:2 offset1:3
    ds_read2_b64 v[20:23], v98 offset0:2 offset1:3
    ds_read_b128 v[24:27], v78
    v_cmp_gt_u32_e64 s[32:33], s29, v1
    s_waitcnt lgkmcnt(5)
    buffer_store_dwordx4 v[8:11], v89, s[16:19], s24 offen sc1
    s_waitcnt lgkmcnt(4)
    buffer_store_dwordx4 v[12:15], v89, s[16:19], s26 offen sc1
    s_waitcnt lgkmcnt(2)
    v_lshlrev_b32 v28, v91, v28
    v_lshlrev_b32 v29, v91, v29
    v_bfi_b32 v19, s31, v19, v28
    buffer_store_dwordx4 v[16:19], v89, s[16:19], s24 offen offset:128 sc1
    s_waitcnt lgkmcnt(1)
    v_bfi_b32 v23, s31, v23, v29
    buffer_store_dwordx4 v[20:23], v89, s[16:19], s26 offen offset:128 sc1
    s_waitcnt lgkmcnt(0)
    s_mov_b64 exec, s[32:33]
    s_cbranch_execz gs_bin_kernel_done
    buffer_store_dwordx4 v[24:27], v1, s[16:19], s27 offen sc1
    v_mov_b32 v6, v1
gs_bin_kernel_tl:
    v_add_u32 v6, 16384, v6
    v_add_u32 v78, 16384, v78
    v_cmpx_gt_u32 vcc, s29, v6
    s_cbranch_execz gs_bin_kernel_done
    ds_read_b128 v[32:35], v78
    s_waitcnt lgkmcnt(0)
    buffer_store_dwordx4 v[32:35], v6, s[16:19], s27 offen sc1
    s_waitcnt vmcnt(0)
    s_branch gs_bin_kernel_tl
gs_bin_kernel_done:
    s_mov_b64 exec, -1
gs_bin_kernel_end:
    s_endpgm
.p2align 8
.type gather_scatter__molecular_angular_gemnet__graph_kernel,@function
gather_scatter__molecular_angular_gemnet__graph_kernel:
    s_cmp_ge_u32 s2, 256
    s_cbranch_scc1 gather_scatter__molecular_angular_gemnet__graph_kernel_end
    s_setprio 3
    s_load_dwordx2 s[4:5], s[0:1], 104
    s_load_dwordx2 s[8:9], s[0:1], 0
    s_load_dwordx2 s[16:17], s[0:1], 24
    s_load_dwordx2 s[34:35], s[0:1], 40
    s_load_dwordx2 s[96:97], s[0:1], 56
    s_load_dwordx2 s[92:93], s[0:1], 64
    s_load_dwordx4 s[20:23], s[0:1], 72
    s_load_dwordx2 s[12:13], s[0:1], 88
    s_and_b32 s3, s2, 7
    s_lshl_b32 s3, s3, 5
    s_lshr_b32 s24, s2, 3
    s_add_u32 s3, s3, s24
    v_and_b32 v1, 63, v0
    v_lshrrev_b32 v108, 6, v0
    v_lshlrev_b32 v22, 2, v0
    v_lshlrev_b32 v5, 3, v0
    v_lshlrev_b32 v112, 4, v0
    v_readfirstlane_b32 s32, v108
    v_mov_b32 v116, 0
    v_cmp_gt_u32 vcc, 164, v0
    s_mov_b64 exec, vcc
    ds_write_b32 v22, v116 offset:2576
    s_mov_b64 exec, -1
    v_lshrrev_b32 v113, 3, v1
    v_lshl_add_u32 v114, v108, 4, v113
    v_lshlrev_b32 v113, 16, v114
    v_and_b32 v109, 7, v1
    v_lshl_add_u32 v113, v109, 4, v113
    s_lshl_b32 s25, s3, 8
    v_add_u32 v113, s25, v113
    s_mov_b32 s24, 0x80000
    s_mul_i32 s26, s3, 5000
    s_mul_i32 s27, s3, 1250
    v_add_u32 v6, s26, v5
    v_lshl_add_u32 v20, v0, 1, s27
    v_cmp_gt_u32 vcc, 625, v0
    s_mov_b64 s[100:101], vcc
    v_lshrrev_b32 v116, 1, v1
    v_mul_u32_u24 v117, 43, v116
    v_lshrrev_b32 v117, 7, v117
    v_mul_u32_u24 v118, 3, v117
    v_sub_u32 v118, v116, v118
    v_cmp_gt_u32 vcc, 48, v1
    v_subrev_u32 v116, 24, v116
    s_nop 0
    v_cndmask_b32 v117, v116, v117, vcc
    v_cndmask_b32 v118, 3, v118, vcc
    v_and_b32 v116, 1, v1
    v_lshlrev_b32 v29, 6, v118
    v_lshl_add_u32 v29, v116, 5, v29
    v_lshl_add_u32 v29, v117, 1, v29
    v_lshl_add_u32 v29, v108, 10, v29
    v_and_b32 v116, 3, v1
    v_lshlrev_b32 v30, 4, v116
    v_lshl_add_u32 v30, v108, 10, v30
    v_lshlrev_b32 v28, 2, v1
    v_subrev_u32 v116, 192, v28
    v_cndmask_b32 v28, v116, v28, vcc
    s_waitcnt lgkmcnt(0)
    s_mov_b32 s6, 37257216
    s_mov_b32 s7, 0x20000
    s_mov_b32 s10, 1280000
    s_mov_b32 s11, 0x20000
    s_mov_b32 s18, 320000
    s_mov_b32 s19, 0x20000
    s_mov_b32 s94, 192
    s_mov_b32 s95, 0x20000
    s_mov_b32 s98, 64
    s_mov_b32 s99, 0x20000
    s_cmp_ge_u32 s32, 10
    s_cbranch_scc1 gather_scatter__molecular_angular_gemnet__graph_kernel_nowv
    s_mov_b32 exec_lo, -1
    s_mov_b32 exec_hi, 0xffff
    buffer_load_dword v28, v28, s[92:95], 0 offen
    s_mov_b32 exec_lo, 0
    s_mov_b32 exec_hi, 0xffff0000
    buffer_load_dword v28, v28, s[96:99], 0 offen
    s_mov_b64 exec, -1
gather_scatter__molecular_angular_gemnet__graph_kernel_nowv:
    s_cmp_lt_u32 s32, 8
    s_cbranch_scc1 gather_scatter__molecular_angular_gemnet__graph_kernel_b0a
    s_barrier
gather_scatter__molecular_angular_gemnet__graph_kernel_b0a:
    buffer_load_dwordx4 v[72:75], v113, s[4:7], 0 offen
    buffer_load_dwordx4 v[76:79], v113, s[4:7], 0 offen offset:128
    s_mov_b64 exec, s[100:101]
    buffer_load_ushort v20, v20, s[16:19], 0 offen
    s_mov_b64 exec, -1
    buffer_load_dwordx4 v[80:83], v113, s[4:7], s24 offen
    buffer_load_dwordx4 v[84:87], v113, s[4:7], s24 offen offset:128
    s_mov_b64 exec, s[100:101]
    buffer_load_dwordx2 v[6:7], v6, s[8:11], 0 offen
    s_mov_b64 exec, -1
    s_setprio 0
    s_cmp_ge_u32 s32, 8
    s_cbranch_scc1 gather_scatter__molecular_angular_gemnet__graph_kernel_b0b
    s_barrier
gather_scatter__molecular_angular_gemnet__graph_kernel_b0b:
    s_cmp_ge_u32 s32, 10
    s_cbranch_scc1 gather_scatter__molecular_angular_gemnet__graph_kernel_now
    s_load_dwordx4 s[28:31], s[34:35], 0
    s_load_dword s33, s[20:21], 0
    s_load_dword s33, s[22:23], 0
gather_scatter__molecular_angular_gemnet__graph_kernel_now:
    s_add_u32 s12, s12, s26
    s_addc_u32 s13, s13, 0
    s_mov_b32 s14, 5000
    s_mov_b32 s15, 0x20000
    v_lshrrev_b32 v19, 2, v1
    v_and_b32 v110, 1, v19
    v_lshl_add_u32 v110, v110, 3, v114
    v_mul_u32_u24 v17, 10000, v110
    v_and_b32 v18, 3, v1
    v_lshlrev_b32 v19, 4, v19
    v_mov_b32 v116, 0
    v_mov_b32 v117, 0
    v_mov_b32 v118, 0
    v_mov_b32 v119, 0
    v_mov_b32 v4, 1
    s_mov_b64 exec, s[100:101]
    ds_write_b128 v112, v[116:119] offset:3232
    s_mov_b64 exec, -1
    v_cmp_gt_u32 vcc, 644, v0
    s_mov_b64 exec, vcc
    ds_write_b32 v22, v116 offset:0
    s_mov_b64 exec, -1
    v_add_u32 v110, 0x1d650, v112
    ds_write_b128 v110, v[116:119] offset:0
    ds_write_b128 v110, v[116:119] offset:16384
    v_cmp_gt_u32 vcc, 320, v0
    s_mov_b64 exec, vcc
    ds_write_b128 v110, v[116:119] offset:32768
    s_mov_b64 exec, -1
    v_mov_b32 v10, 0
    v_mov_b32 v11, 0
    v_mov_b32 v12, 0
    v_mov_b32 v13, 0
    v_lshl_add_u32 v14, v108, 7, v1
    v_lshlrev_b32 v108, 4, v18
    v_mov_b32 v109, 0x3f80
    v_cmp_gt_u32 vcc, 2, v18
    v_lshlrev_b32 v111, v108, v109
    s_nop 0
    v_cndmask_b32 v2, 0, v111, vcc
    v_cndmask_b32_e64 v3, v111, 0, vcc
    s_cmp_ge_u32 s32, 10
    s_cbranch_scc1 gather_scatter__molecular_angular_gemnet__graph_kernel_notab
    s_mov_b64 exec, -1
    s_waitcnt vmcnt(3)
    ds_write_b16 v29, v28 offset:13232
    ds_write_b16_d16_hi v29, v28 offset:13248
    ds_read_b128 v[32:35], v30 offset:13232
    ds_read_b128 v[36:39], v30 offset:13296
    ds_read_b128 v[40:43], v30 offset:13360
    ds_read_b128 v[44:47], v30 offset:13424
    s_waitcnt lgkmcnt(0)
    v_lshlrev_b32 v20, 16, v20
    s_lshl_b32 s26, s28, 16
    s_and_b32 s27, s28, 0xffff0000
    v_subrev_f32 v100, s26, v20
    v_subrev_f32 v101, s27, v20
    v_cvt_pk_bf16_f32 v102, v100, v101
    v_lshlrev_b32 v100, 16, v102
    v_and_b32 v101, 0xffff0000, v102
    v_mul_f32 v100, v100, v100
    v_mul_f32 v101, v101, v101
    v_cvt_pk_bf16_f32 v102, v100, v101
    v_lshlrev_b32 v100, 16, v102
    v_and_b32 v101, 0xffff0000, v102
    v_mul_f32 v100, 0xc1200000, v100
    v_mul_f32 v101, 0xc1200000, v101
    v_cvt_pk_bf16_f32 v102, v100, v101
    v_lshlrev_b32 v100, 16, v102
    v_and_b32 v101, 0xffff0000, v102
    v_mul_f32 v100, 0x3fb8aa3b, v100
    v_mul_f32 v101, 0x3fb8aa3b, v101
    v_exp_f32 v100, v100
    v_exp_f32 v101, v101
    s_nop 0
    v_cvt_pk_bf16_f32 v104, v100, v101
    s_lshl_b32 s26, s29, 16
    s_and_b32 s27, s29, 0xffff0000
    v_subrev_f32 v100, s26, v20
    v_subrev_f32 v101, s27, v20
    v_cvt_pk_bf16_f32 v102, v100, v101
    v_lshlrev_b32 v100, 16, v102
    v_and_b32 v101, 0xffff0000, v102
    v_mul_f32 v100, v100, v100
    v_mul_f32 v101, v101, v101
    v_cvt_pk_bf16_f32 v102, v100, v101
    v_lshlrev_b32 v100, 16, v102
    v_and_b32 v101, 0xffff0000, v102
    v_mul_f32 v100, 0xc1200000, v100
    v_mul_f32 v101, 0xc1200000, v101
    v_cvt_pk_bf16_f32 v102, v100, v101
    v_lshlrev_b32 v100, 16, v102
    v_and_b32 v101, 0xffff0000, v102
    v_mul_f32 v100, 0x3fb8aa3b, v100
    v_mul_f32 v101, 0x3fb8aa3b, v101
    v_exp_f32 v100, v100
    v_exp_f32 v101, v101
    s_nop 0
    v_cvt_pk_bf16_f32 v105, v100, v101
    s_lshl_b32 s26, s30, 16
    s_and_b32 s27, s30, 0xffff0000
    v_subrev_f32 v100, s26, v20
    v_subrev_f32 v101, s27, v20
    v_cvt_pk_bf16_f32 v102, v100, v101
    v_lshlrev_b32 v100, 16, v102
    v_and_b32 v101, 0xffff0000, v102
    v_mul_f32 v100, v100, v100
    v_mul_f32 v101, v101, v101
    v_cvt_pk_bf16_f32 v102, v100, v101
    v_lshlrev_b32 v100, 16, v102
    v_and_b32 v101, 0xffff0000, v102
    v_mul_f32 v100, 0xc1200000, v100
    v_mul_f32 v101, 0xc1200000, v101
    v_cvt_pk_bf16_f32 v102, v100, v101
    v_lshlrev_b32 v100, 16, v102
    v_and_b32 v101, 0xffff0000, v102
    v_mul_f32 v100, 0x3fb8aa3b, v100
    v_mul_f32 v101, 0x3fb8aa3b, v101
    v_exp_f32 v100, v100
    v_exp_f32 v101, v101
    s_nop 0
    v_cvt_pk_bf16_f32 v106, v100, v101
    s_lshl_b32 s26, s31, 16
    s_and_b32 s27, s31, 0xffff0000
    v_subrev_f32 v100, s26, v20
    v_subrev_f32 v101, s27, v20
    v_cvt_pk_bf16_f32 v102, v100, v101
    v_lshlrev_b32 v100, 16, v102
    v_and_b32 v101, 0xffff0000, v102
    v_mul_f32 v100, v100, v100
    v_mul_f32 v101, v101, v101
    v_cvt_pk_bf16_f32 v102, v100, v101
    v_lshlrev_b32 v100, 16, v102
    v_and_b32 v101, 0xffff0000, v102
    v_mul_f32 v100, 0xc1200000, v100
    v_mul_f32 v101, 0xc1200000, v101
    v_cvt_pk_bf16_f32 v102, v100, v101
    v_lshlrev_b32 v100, 16, v102
    v_and_b32 v101, 0xffff0000, v102
    v_mul_f32 v100, 0x3fb8aa3b, v100
    v_mul_f32 v101, 0x3fb8aa3b, v101
    v_exp_f32 v100, v100
    v_exp_f32 v101, v101
    s_nop 0
    v_cvt_pk_bf16_f32 v107, v100, v101
    s_nop 1
    v_mfma_f32_4x4x4_16b_bf16 v[60:63], v[32:33], v[104:105], 0
    v_mfma_f32_4x4x4_16b_bf16 v[64:67], v[36:37], v[104:105], 0
    v_mfma_f32_4x4x4_16b_bf16 v[68:71], v[40:41], v[104:105], 0
    v_mfma_f32_4x4x4_16b_bf16 v[48:51], v[44:45], v[104:105], 0
    v_mfma_f32_4x4x4_16b_bf16 v[60:63], v[34:35], v[106:107], v[60:63]
    v_mfma_f32_4x4x4_16b_bf16 v[64:67], v[38:39], v[106:107], v[64:67]
    v_mfma_f32_4x4x4_16b_bf16 v[68:71], v[42:43], v[106:107], v[68:71]
    v_mfma_f32_4x4x4_16b_bf16 v[48:51], v[46:47], v[106:107], v[48:51]
    s_nop 4
    v_cvt_pk_bf16_f32 v92, v60, v64
    v_cvt_pk_bf16_f32 v93, v61, v65
    v_cvt_pk_bf16_f32 v94, v62, v66
    v_cvt_pk_bf16_f32 v95, v63, v67
    v_cvt_pk_bf16_f32 v96, v68, v69
    v_cvt_pk_bf16_f32 v97, v70, v71
    s_nop 1
    v_cvt_pk_bf16_f32 v98, v48, v49
    v_cvt_pk_bf16_f32 v99, v50, v51
    s_mov_b64 exec, s[100:101]
    ds_write_b128 v112, v[92:95] offset:13232
    ds_write_b64 v5, v[96:97] offset:23232
    s_mov_b64 exec, -1
    v_mov_b32 v8, v98
    v_mov_b32 v9, v99
gather_scatter__molecular_angular_gemnet__graph_kernel_notab:
    v_mov_b32 v56, 3216
    s_mov_b64 exec, -1
    s_waitcnt vmcnt(5)
    s_waitcnt vmcnt(4)
    v_lshrrev_b32 v126, 16, v79
    v_and_b32 v124, 7, v1
    s_nop 0
    v_sub_u32_dpp v124, v126, v124 quad_perm:[1,1,3,3] row_mask:0xf bank_mask:0xf
    v_lshrrev_b32 v30, 21, v73
    v_cmp_lt_i32_e64 s[42:43], 8, v124
    v_and_b32 v30, 0x7fc, v30
    v_mov_b32 v48, v73
    s_mov_b64 exec, s[42:43]
    ds_add_rtn_u32 v31, v30, v4 offset:2576
    v_lshrrev_b32 v49, 16, v77
    s_mov_b64 exec, -1
    v_lshrrev_b32 v32, 21, v74
    v_cmp_lt_i32_e64 s[44:45], 16, v124
    v_and_b32 v32, 0x7fc, v32
    v_mov_b32 v50, v74
    s_mov_b64 exec, s[44:45]
    ds_add_rtn_u32 v33, v32, v4 offset:2576
    v_mov_b32 v51, v78
    s_mov_b64 exec, -1
    v_lshrrev_b32 v34, 21, v75
    v_cmp_lt_i32_e64 s[46:47], 24, v124
    v_and_b32 v34, 0x7fc, v34
    v_mov_b32 v52, v75
    s_mov_b64 exec, s[46:47]
    ds_add_rtn_u32 v35, v34, v4 offset:2576
    v_lshrrev_b32 v53, 16, v78
    s_mov_b64 exec, -1
    v_lshrrev_b32 v36, 21, v76
    v_cmp_lt_i32_e64 s[48:49], 32, v124
    v_and_b32 v36, 0x7fc, v36
    v_mov_b32 v58, v76
    s_mov_b64 exec, s[48:49]
    ds_add_rtn_u32 v37, v36, v4 offset:2576
    v_mov_b32 v59, v79
    s_mov_b64 exec, -1
    s_waitcnt vmcnt(2)
    s_waitcnt vmcnt(1)
    v_lshrrev_b32 v127, 16, v87
    v_and_b32 v125, 7, v1
    s_nop 0
    v_sub_u32_dpp v125, v127, v125 quad_perm:[1,1,3,3] row_mask:0xf bank_mask:0xf
    v_lshrrev_b32 v38, 21, v80
    v_cmp_lt_i32_e64 s[50:51], 0, v125
    v_and_b32 v38, 0x7fc, v38
    v_mov_b32 v60, v80
    s_mov_b64 exec, s[50:51]
    ds_add_rtn_u32 v39, v38, v4 offset:2576
    v_mov_b32 v61, v85
    s_mov_b64 exec, -1
    v_lshrrev_b32 v40, 21, v81
    v_cmp_lt_i32_e64 s[52:53], 8, v125
    v_and_b32 v40, 0x7fc, v40
    v_mov_b32 v62, v81
    s_mov_b64 exec, s[52:53]
    ds_add_rtn_u32 v41, v40, v4 offset:2576
    v_lshrrev_b32 v63, 16, v85
    s_mov_b64 exec, -1
    v_lshrrev_b32 v42, 21, v82
    v_cmp_lt_i32_e64 s[54:55], 16, v125
    v_and_b32 v42, 0x7fc, v42
    v_mov_b32 v64, v82
    s_mov_b64 exec, s[54:55]
    ds_add_rtn_u32 v43, v42, v4 offset:2576
    v_mov_b32 v65, v86
    s_mov_b64 exec, -1
    v_lshrrev_b32 v44, 21, v83
    v_cmp_lt_i32_e64 s[56:57], 24, v125
    v_and_b32 v44, 0x7fc, v44
    v_mov_b32 v66, v83
    s_mov_b64 exec, s[56:57]
    ds_add_rtn_u32 v45, v44, v4 offset:2576
    v_lshrrev_b32 v67, 16, v86
    s_mov_b64 exec, -1
    v_lshrrev_b32 v46, 21, v84
    v_cmp_lt_i32_e64 s[58:59], 32, v125
    v_and_b32 v46, 0x7fc, v46
    v_mov_b32 v68, v84
    s_mov_b64 exec, s[58:59]
    ds_add_rtn_u32 v47, v46, v4 offset:2576
    v_mov_b32 v69, v87
    s_mov_b64 exec, s[42:43]
    s_waitcnt lgkmcnt(8)
    v_cmp_le_u32_e64 s[72:73], 64, v31
    v_lshlrev_b32 v31, 3, v31
    v_lshl_add_u32 v30, v30, 7, v31
    s_mov_b64 exec, s[44:45]
    s_waitcnt lgkmcnt(7)
    v_cmp_le_u32_e64 s[74:75], 64, v33
    v_lshlrev_b32 v33, 3, v33
    v_lshl_add_u32 v32, v32, 7, v33
    s_mov_b64 exec, s[46:47]
    s_waitcnt lgkmcnt(6)
    v_cmp_le_u32_e64 s[76:77], 64, v35
    v_lshlrev_b32 v35, 3, v35
    v_lshl_add_u32 v34, v34, 7, v35
    s_mov_b64 exec, s[48:49]
    s_waitcnt lgkmcnt(5)
    v_cmp_le_u32_e64 s[78:79], 64, v37
    v_lshlrev_b32 v37, 3, v37
    v_lshl_add_u32 v36, v36, 7, v37
    s_mov_b64 exec, s[50:51]
    s_waitcnt lgkmcnt(4)
    v_cmp_le_u32_e64 s[80:81], 64, v39
    v_lshlrev_b32 v39, 3, v39
    v_lshl_add_u32 v38, v38, 7, v39
    s_mov_b64 exec, s[52:53]
    s_waitcnt lgkmcnt(3)
    v_cmp_le_u32_e64 s[82:83], 64, v41
    v_lshlrev_b32 v41, 3, v41
    v_lshl_add_u32 v40, v40, 7, v41
    s_mov_b64 exec, s[54:55]
    s_waitcnt lgkmcnt(2)
    v_cmp_le_u32_e64 s[84:85], 64, v43
    v_lshlrev_b32 v43, 3, v43
    v_lshl_add_u32 v42, v42, 7, v43
    s_mov_b64 exec, s[56:57]
    s_waitcnt lgkmcnt(1)
    v_cmp_le_u32_e64 s[86:87], 64, v45
    v_lshlrev_b32 v45, 3, v45
    v_lshl_add_u32 v44, v44, 7, v45
    s_mov_b64 exec, s[58:59]
    s_waitcnt lgkmcnt(0)
    v_cmp_le_u32_e64 s[88:89], 64, v47
    v_lshlrev_b32 v47, 3, v47
    v_lshl_add_u32 v46, v46, 7, v47
    s_mov_b64 s[70:71], s[72:73]
    s_or_b64 s[70:71], s[70:71], s[74:75]
    s_or_b64 s[70:71], s[70:71], s[76:77]
    s_or_b64 s[70:71], s[70:71], s[78:79]
    s_or_b64 s[70:71], s[70:71], s[80:81]
    s_or_b64 s[70:71], s[70:71], s[82:83]
    s_or_b64 s[70:71], s[70:71], s[84:85]
    s_or_b64 s[70:71], s[70:71], s[86:87]
    s_or_b64 s[70:71], s[70:71], s[88:89]
    s_cbranch_scc0 gather_scatter__molecular_angular_gemnet__graph_kernel_nokov
    s_mov_b64 exec, s[72:73]
    ds_add_rtn_u32 v31, v56, v4
    s_mov_b64 exec, s[74:75]
    ds_add_rtn_u32 v33, v56, v4
    s_mov_b64 exec, s[76:77]
    ds_add_rtn_u32 v35, v56, v4
    s_mov_b64 exec, s[78:79]
    ds_add_rtn_u32 v37, v56, v4
    s_mov_b64 exec, s[80:81]
    ds_add_rtn_u32 v39, v56, v4
    s_mov_b64 exec, s[82:83]
    ds_add_rtn_u32 v41, v56, v4
    s_mov_b64 exec, s[84:85]
    ds_add_rtn_u32 v43, v56, v4
    s_mov_b64 exec, s[86:87]
    ds_add_rtn_u32 v45, v56, v4
    s_mov_b64 exec, s[88:89]
    ds_add_rtn_u32 v47, v56, v4
    s_mov_b64 exec, s[72:73]
    s_waitcnt lgkmcnt(8)
    v_min_u32 v31, 1024, v31
    v_lshlrev_b32 v31, 3, v31
    v_add_u32 v30, 81920, v31
    s_mov_b64 exec, s[74:75]
    s_waitcnt lgkmcnt(7)
    v_min_u32 v33, 1024, v33
    v_lshlrev_b32 v33, 3, v33
    v_add_u32 v32, 81920, v33
    s_mov_b64 exec, s[76:77]
    s_waitcnt lgkmcnt(6)
    v_min_u32 v35, 1024, v35
    v_lshlrev_b32 v35, 3, v35
    v_add_u32 v34, 81920, v35
    s_mov_b64 exec, s[78:79]
    s_waitcnt lgkmcnt(5)
    v_min_u32 v37, 1024, v37
    v_lshlrev_b32 v37, 3, v37
    v_add_u32 v36, 81920, v37
    s_mov_b64 exec, s[80:81]
    s_waitcnt lgkmcnt(4)
    v_min_u32 v39, 1024, v39
    v_lshlrev_b32 v39, 3, v39
    v_add_u32 v38, 81920, v39
    s_mov_b64 exec, s[82:83]
    s_waitcnt lgkmcnt(3)
    v_min_u32 v41, 1024, v41
    v_lshlrev_b32 v41, 3, v41
    v_add_u32 v40, 81920, v41
    s_mov_b64 exec, s[84:85]
    s_waitcnt lgkmcnt(2)
    v_min_u32 v43, 1024, v43
    v_lshlrev_b32 v43, 3, v43
    v_add_u32 v42, 81920, v43
    s_mov_b64 exec, s[86:87]
    s_waitcnt lgkmcnt(1)
    v_min_u32 v45, 1024, v45
    v_lshlrev_b32 v45, 3, v45
    v_add_u32 v44, 81920, v45
    s_mov_b64 exec, s[88:89]
    s_waitcnt lgkmcnt(0)
    v_min_u32 v47, 1024, v47
    v_lshlrev_b32 v47, 3, v47
    v_add_u32 v46, 81920, v47
gather_scatter__molecular_angular_gemnet__graph_kernel_nokov:
    s_mov_b64 exec, s[42:43]
    ds_write_b64 v30, v[48:49] offset:30288
    s_mov_b64 exec, s[44:45]
    ds_write_b64 v32, v[50:51] offset:30288
    s_mov_b64 exec, s[46:47]
    ds_write_b64 v34, v[52:53] offset:30288
    s_mov_b64 exec, s[48:49]
    ds_write_b64 v36, v[58:59] offset:30288
    s_mov_b64 exec, s[50:51]
    ds_write_b64 v38, v[60:61] offset:30288
    s_mov_b64 exec, s[52:53]
    ds_write_b64 v40, v[62:63] offset:30288
    s_mov_b64 exec, s[54:55]
    ds_write_b64 v42, v[64:65] offset:30288
    s_mov_b64 exec, s[56:57]
    ds_write_b64 v44, v[66:67] offset:30288
    s_mov_b64 exec, s[58:59]
    ds_write_b64 v46, v[68:69] offset:30288
    s_mov_b64 exec, -1
    s_load_dwordx8 s[72:79], s[20:21], 0
    s_load_dwordx8 s[80:87], s[22:23], 0
    s_mov_b32 s88, 0x1000000
    s_movk_i32 s89, 5120
    s_mov_b32 s34, 0
    s_mov_b64 exec, -1
    v_cmp_lt_i32_e64 s[40:41], 0, v124
    s_mov_b64 exec, s[40:41]
    v_lshrrev_b32 v24, 10, v72
    v_and_b32 v72, 0x3ff, v72
    buffer_load_dwordx2 v[24:25], v24, s[8:11], 0 offen
    v_lshlrev_b32 v72, 3, v72
    s_mov_b64 exec, -1
    s_lshl_b32 s90, s32, 9
    s_add_u32 s90, s90, 30288
    v_lshl_add_u32 v120, v1, 3, s90
    v_add_u32 v121, 65536, v120
    s_lshl_b32 s90, s32, 2
    v_lshl_add_u32 v123, v1, 6, s90
    v_min_u32 v123, 640, v123
    s_waitcnt lgkmcnt(0)
    s_pack_ll_b32_b16 s24, s72, s74
    s_pack_ll_b32_b16 s25, s76, s78
    s_pack_hh_b32_b16 s26, s72, s74
    s_pack_hh_b32_b16 s27, s76, s78
    s_pack_ll_b32_b16 s28, s73, s75
    s_pack_ll_b32_b16 s29, s77, s79
    s_pack_hh_b32_b16 s30, s73, s75
    s_pack_hh_b32_b16 s31, s77, s79
    s_pack_ll_b32_b16 s16, s80, s82
    s_pack_ll_b32_b16 s17, s84, s86
    s_pack_hh_b32_b16 s18, s80, s82
    s_pack_hh_b32_b16 s19, s84, s86
    s_pack_ll_b32_b16 s20, s81, s83
    s_pack_ll_b32_b16 s21, s85, s87
    s_pack_hh_b32_b16 s22, s81, s83
    s_pack_hh_b32_b16 s23, s85, s87
    s_barrier
    ds_read_b32 v123, v123 offset:2576
    ds_read_b64 v[74:75], v120 offset:0
    ds_read_b64 v[78:79], v120 offset:8192
    ds_read_b64 v[80:81], v120 offset:16384
    ds_read_b64 v[82:83], v120 offset:24576
    ds_read_b64 v[84:85], v120 offset:32768
    ds_read_b64 v[86:87], v120 offset:40960
    ds_read_b64 v[58:59], v120 offset:49152
    ds_read_b64 v[60:61], v120 offset:57344
    ds_read_b64 v[62:63], v121 offset:0
    ds_read_b64 v[64:65], v121 offset:8192
    ds_read_b64 v[66:67], v121 offset:16384
    s_waitcnt lgkmcnt(11)
    v_readlane_b32 s72, v123, 0
    v_readlane_b32 s73, v123, 1
    v_readlane_b32 s74, v123, 2
    v_readlane_b32 s75, v123, 3
    v_readlane_b32 s76, v123, 4
    v_readlane_b32 s77, v123, 5
    v_readlane_b32 s78, v123, 6
    v_readlane_b32 s79, v123, 7
    v_readlane_b32 s80, v123, 8
    v_readlane_b32 s81, v123, 9
    v_readlane_b32 s82, v123, 10
    s_lshl_b32 s90, s32, 6
    s_cmp_gt_u32 s82, 1024
    s_cbranch_scc1 gather_scatter__molecular_angular_gemnet__graph_kernel_slow
    s_sub_i32 s82, s82, s90
    v_cmp_gt_i32_e64 s[42:43], s72, v1
    v_cmp_gt_i32_e64 s[44:45], s73, v1
    v_cmp_gt_i32_e64 s[46:47], s74, v1
    v_cmp_gt_i32_e64 s[48:49], s75, v1
    v_cmp_gt_i32_e64 s[50:51], s76, v1
    v_cmp_gt_i32_e64 s[52:53], s77, v1
    v_cmp_gt_i32_e64 s[54:55], s78, v1
    v_cmp_gt_i32_e64 s[56:57], s79, v1
    v_cmp_gt_i32_e64 s[58:59], s80, v1
    v_cmp_gt_i32_e64 s[60:61], s81, v1
    v_cmp_gt_i32_e64 s[62:63], s82, v1
    s_waitcnt lgkmcnt(10)
    s_mov_b64 exec, s[42:43]
    v_lshrrev_b32 v26, 10, v74
    v_and_b32 v74, 0x3ff, v74
    buffer_load_dwordx2 v[26:27], v26, s[8:11], 0 offen
    v_lshlrev_b32 v74, 3, v74
    s_waitcnt lgkmcnt(9)
    s_mov_b64 exec, s[44:45]
    v_lshrrev_b32 v28, 10, v78
    v_and_b32 v78, 0x3ff, v78
    buffer_load_dwordx2 v[28:29], v28, s[8:11], 0 offen
    v_lshlrev_b32 v78, 3, v78
    s_mov_b64 exec, -1
    v_mov_b32 v116, 0
    v_mov_b32 v117, 0
    v_mov_b32 v118, 0
    v_mov_b32 v119, 0
    v_lshrrev_b32 v108, 5, v1
    v_and_b32 v109, 31, v1
    v_lshlrev_b32 v108, 13, v108
    v_lshl_add_u32 v108, v109, 4, v108
    s_lshl_b32 s90, s32, 9
    s_add_u32 s90, s90, 30288
    v_add_u32 v108, s90, v108
    v_add_u32 v110, 65536, v108
    s_waitcnt lgkmcnt(0)
    ds_write_b128 v108, v[116:119] offset:0
    ds_write_b128 v108, v[116:119] offset:16384
    ds_write_b128 v108, v[116:119] offset:32768
    ds_write_b128 v108, v[116:119] offset:49152
    ds_write_b128 v110, v[116:119] offset:0
    s_mov_b32 exec_hi, 0
    ds_write_b128 v110, v[116:119] offset:16384
    s_mov_b32 exec_lo, 0x11111111
    s_mov_b32 exec_hi, 0x11111111
    v_mov_b32 v122, s24
    v_mov_b32 v123, s25
    s_mov_b32 exec_lo, 0x22222222
    s_mov_b32 exec_hi, 0x22222222
    v_mov_b32 v122, s26
    v_mov_b32 v123, s27
    s_mov_b32 exec_lo, 0x44444444
    s_mov_b32 exec_hi, 0x44444444
    v_mov_b32 v122, s28
    v_mov_b32 v123, s29
    s_mov_b32 exec_lo, 0x88888888
    s_mov_b32 exec_hi, 0x88888888
    v_mov_b32 v122, s30
    v_mov_b32 v123, s31
    s_mov_b64 exec, -1
    s_waitcnt lgkmcnt(0)
    s_barrier
    s_mov_b64 exec, s[40:41]
    v_lshrrev_b32 v116, 1, v72
    ds_add_rtn_u32 v54, v116, v4 offset:0
    s_mov_b64 exec, s[42:43]
    v_lshrrev_b32 v117, 1, v74
    ds_add_rtn_u32 v55, v117, v4 offset:0
    s_mov_b64 exec, s[40:41]
    v_lshlrev_b32 v98, 1, v72
    ds_read_b128 v[92:95], v98 offset:13232
    ds_read_b64 v[96:97], v72 offset:23232
    s_mov_b64 exec, s[46:47]
    v_lshrrev_b32 v30, 10, v80
    v_and_b32 v80, 0x3ff, v80
    buffer_load_dwordx2 v[30:31], v30, s[8:11], 0 offen
    v_lshlrev_b32 v80, 3, v80
    s_mov_b64 exec, -1
    s_mov_b32 s38, 0x0f0f0f0f
    s_mov_b32 s39, 0x0f0f0f0f
    v_cndmask_b32_e64 v108, v127, v126, s[38:39]
    s_nop 1
    v_mov_b32_dpp v109, v108 quad_perm:[0,0,2,2] row_mask:0xf bank_mask:0xf
    v_mov_b32_dpp v15, v108 quad_perm:[1,1,3,3] row_mask:0xf bank_mask:0xf
    v_cmp_eq_u32 vcc, 0, v18
    v_add_u32 v17, v109, v17
    v_subrev_u32 v15, 40, v15
    v_max_i32 v15, 0, v15
    v_cndmask_b32 v16, 0, v15, vcc
    s_nop 1
    v_add_u32_dpp v16, v16, v16 row_shr:1 row_mask:0xf bank_mask:0xf bound_ctrl:0
    s_nop 1
    v_add_u32_dpp v16, v16, v16 row_shr:2 row_mask:0xf bank_mask:0xf bound_ctrl:0
    s_nop 1
    v_add_u32_dpp v16, v16, v16 row_shr:4 row_mask:0xf bank_mask:0xf bound_ctrl:0
    s_nop 1
    v_add_u32_dpp v16, v16, v16 row_shr:8 row_mask:0xf bank_mask:0xf bound_ctrl:0
    s_nop 1
    v_add_u32_dpp v16, v16, v16 row_bcast:15 row_mask:0xa bank_mask:0xf
    s_nop 1
    v_add_u32_dpp v16, v16, v16 row_bcast:31 row_mask:0xc bank_mask:0xf
    s_nop 0
    v_readlane_b32 s35, v16, 63
    v_sub_u32 v16, v16, v15
    v_sub_u32 v17, v17, v16
    s_add_u32 s37, s34, 128
    v_sub_u32 v108, s34, v16
    v_sub_u32 v109, s37, v16
    v_max_i32 v108, 0, v108
    v_min_i32 v109, v109, v15
    v_add_u32 v108, v108, v18
    v_add_u32 v110, v108, v16
    v_subrev_u32 v110, s34, v110
    v_lshl_add_u32 v110, s32, 7, v110
    s_sub_u32 s36, s35, s34
    s_min_i32 s36, s36, 128
gather_scatter__molecular_angular_gemnet__graph_kernel_lloopa:
    v_cmpx_lt_i32 vcc, v108, v109
    s_cbranch_execz gather_scatter__molecular_angular_gemnet__graph_kernel_ldonea
    ds_write_b8 v110, v19 offset:28240
    v_add_u32 v108, 4, v108
    v_add_u32 v110, 4, v110
    s_branch gather_scatter__molecular_angular_gemnet__graph_kernel_lloopa
gather_scatter__molecular_angular_gemnet__graph_kernel_ldonea:
    s_mov_b64 exec, -1
    ds_read_u8 v88, v14 offset:28240
    ds_read_u8 v90, v14 offset:28304
    s_sub_i32 s37, s36, 0
    v_cmp_gt_i32_e64 s[64:65], s37, v1
    s_sub_i32 s37, s36, 64
    v_cmp_gt_i32_e64 s[66:67], s37, v1
    v_add_u32 v111, s34, v1
    s_waitcnt lgkmcnt(0)
    ds_bpermute_b32 v88, v88, v17
    ds_bpermute_b32 v90, v90, v17
    s_waitcnt lgkmcnt(0)
    v_add_lshl_u32 v88, v88, v111, 3
    v_add_lshl_u32 v90, v90, v111, 3
    s_mov_b64 exec, s[64:65]
    buffer_load_dwordx2 v[88:89], v88, s[4:7], s88 offen offset:0
    s_mov_b64 exec, s[66:67]
    buffer_load_dwordx2 v[90:91], v90, s[4:7], s88 offen offset:512
    s_mov_b64 exec, -1
    s_add_u32 s37, s34, 128
    s_cmp_gt_u32 s35, s37
    s_cbranch_scc0 gather_scatter__molecular_angular_gemnet__graph_kernel_nomorea
    v_mov_b32 v112, 2560
    v_mov_b32 v113, s37
    ds_write_b32 v112, v113
gather_scatter__molecular_angular_gemnet__graph_kernel_nomorea:
    s_mov_b64 exec, s[44:45]
    v_lshrrev_b32 v116, 1, v78
    ds_add_rtn_u32 v56, v116, v4 offset:0
    s_mov_b64 exec, s[42:43]
    v_lshlrev_b32 v106, 1, v74
    ds_read_b128 v[100:103], v106 offset:13232
    ds_read_b64 v[104:105], v74 offset:23232
    s_mov_b64 exec, s[40:41]
    v_lshlrev_b32 v112, 16, v77
    v_mul_f32 v112, 0.15915494, v112
    v_fract_f32 v112, v112
    v_cos_f32 v112, v112
    s_nop 0
    v_add_f32 v114, v112, v112
    v_fma_f32 v113, v114, v112, -1.0
    v_fma_f32 v114, v114, v113, -v112
    v_cvt_pk_bf16_f32 v115, v112, v113
    v_cvt_pk_bf16_f32 v114, 0, v114
    v_dot2_f32_bf16 v92, v92, v115, 0
    v_dot2_f32_bf16 v93, v93, v115, 0
    v_dot2_f32_bf16 v94, v94, v115, 0
    v_dot2_f32_bf16 v95, v95, v115, 0
    v_lshlrev_b32 v112, 16, v96
    v_and_b32 v96, 0xffff0000, v96
    v_lshlrev_b32 v113, 16, v97
    v_and_b32 v97, 0xffff0000, v97
    v_fmac_f32 v92, v112, v114
    v_fmac_f32 v93, v96, v114
    v_fmac_f32 v94, v113, v114
    v_fmac_f32 v95, v97, v114
    s_waitcnt vmcnt(5)
    s_mov_b64 exec, -1
    v_mfma_f32_4x4x4_16b_bf16 v[108:111], v[122:123], v[24:25], 0
    s_mov_b64 exec, s[40:41]
    v_min_u32 v99, 25, v54
    v_cmp_le_u32 vcc, 25, v54
    v_mad_u32_u24 v99, v99, s89, v72
    s_nop 0
    v_mul_f32 v108, v108, v92
    v_mul_f32 v109, v109, v93
    v_mul_f32 v110, v110, v94
    v_mul_f32 v111, v111, v95
    v_cvt_pk_bf16_f32 v24, v108, v109
    v_cvt_pk_bf16_f32 v25, v110, v111
    ds_write_b64 v99, v[24:25] offset:30288
    s_cbranch_vccz gather_scatter__molecular_angular_gemnet__graph_kernel_noovfU0
    s_mov_b64 exec, vcc
    v_lshlrev_b32 v98, 1, v72
    ds_add_f32 v98, v108 offset:3232
    ds_add_f32 v98, v109 offset:3236
    ds_add_f32 v98, v110 offset:3240
    ds_add_f32 v98, v111 offset:3244
    s_waitcnt lgkmcnt(0)
gather_scatter__molecular_angular_gemnet__graph_kernel_noovfU0:
    s_mov_b64 exec, s[48:49]
    v_lshrrev_b32 v32, 10, v82
    v_and_b32 v82, 0x3ff, v82
    buffer_load_dwordx2 v[32:33], v32, s[8:11], 0 offen
    v_lshlrev_b32 v82, 3, v82
    s_mov_b64 exec, s[46:47]
    v_lshrrev_b32 v117, 1, v80
    ds_add_rtn_u32 v57, v117, v4 offset:0
    s_mov_b64 exec, s[44:45]
    v_lshlrev_b32 v98, 1, v78
    ds_read_b128 v[92:95], v98 offset:13232
    ds_read_b64 v[96:97], v78 offset:23232
    s_mov_b64 exec, s[42:43]
    v_lshlrev_b32 v112, 16, v75
    v_mul_f32 v112, 0.15915494, v112
    v_fract_f32 v112, v112
    v_cos_f32 v112, v112
    s_nop 0
    v_add_f32 v114, v112, v112
    v_fma_f32 v113, v114, v112, -1.0
    v_fma_f32 v114, v114, v113, -v112
    v_cvt_pk_bf16_f32 v115, v112, v113
    v_cvt_pk_bf16_f32 v114, 0, v114
    s_waitcnt lgkmcnt(4)
    v_dot2_f32_bf16 v100, v100, v115, 0
    v_dot2_f32_bf16 v101, v101, v115, 0
    v_dot2_f32_bf16 v102, v102, v115, 0
    v_dot2_f32_bf16 v103, v103, v115, 0
    v_lshlrev_b32 v112, 16, v104
    v_and_b32 v104, 0xffff0000, v104
    v_lshlrev_b32 v113, 16, v105
    v_and_b32 v105, 0xffff0000, v105
    v_fmac_f32 v100, v112, v114
    v_fmac_f32 v101, v104, v114
    v_fmac_f32 v102, v113, v114
    v_fmac_f32 v103, v105, v114
    s_waitcnt vmcnt(5)
    s_mov_b64 exec, -1
    v_mfma_f32_4x4x4_16b_bf16 v[108:111], v[122:123], v[26:27], 0
    s_mov_b64 exec, s[42:43]
    v_min_u32 v107, 25, v55
    v_cmp_le_u32 vcc, 25, v55
    v_mad_u32_u24 v107, v107, s89, v74
    s_nop 0
    v_mul_f32 v108, v108, v100
    v_mul_f32 v109, v109, v101
    v_mul_f32 v110, v110, v102
    v_mul_f32 v111, v111, v103
    v_cvt_pk_bf16_f32 v26, v108, v109
    v_cvt_pk_bf16_f32 v27, v110, v111
    ds_write_b64 v107, v[26:27] offset:30288
    s_cbranch_vccz gather_scatter__molecular_angular_gemnet__graph_kernel_noovfS0
    s_mov_b64 exec, vcc
    v_lshlrev_b32 v106, 1, v74
    ds_add_f32 v106, v108 offset:3232
    ds_add_f32 v106, v109 offset:3236
    ds_add_f32 v106, v110 offset:3240
    ds_add_f32 v106, v111 offset:3244
    s_waitcnt lgkmcnt(0)
gather_scatter__molecular_angular_gemnet__graph_kernel_noovfS0:
    s_mov_b64 exec, s[50:51]
    v_lshrrev_b32 v34, 10, v84
    v_and_b32 v84, 0x3ff, v84
    buffer_load_dwordx2 v[34:35], v34, s[8:11], 0 offen
    v_lshlrev_b32 v84, 3, v84
    s_mov_b64 exec, s[48:49]
    v_lshrrev_b32 v116, 1, v82
    ds_add_rtn_u32 v54, v116, v4 offset:0
    s_mov_b64 exec, s[46:47]
    v_lshlrev_b32 v106, 1, v80
    ds_read_b128 v[100:103], v106 offset:13232
    ds_read_b64 v[104:105], v80 offset:23232
    s_mov_b64 exec, s[44:45]
    v_lshlrev_b32 v112, 16, v79
    v_mul_f32 v112, 0.15915494, v112
    v_fract_f32 v112, v112
    v_cos_f32 v112, v112
    s_nop 0
    v_add_f32 v114, v112, v112
    v_fma_f32 v113, v114, v112, -1.0
    v_fma_f32 v114, v114, v113, -v112
    v_cvt_pk_bf16_f32 v115, v112, v113
    v_cvt_pk_bf16_f32 v114, 0, v114
    s_waitcnt lgkmcnt(4)
    v_dot2_f32_bf16 v92, v92, v115, 0
    v_dot2_f32_bf16 v93, v93, v115, 0
    v_dot2_f32_bf16 v94, v94, v115, 0
    v_dot2_f32_bf16 v95, v95, v115, 0
    v_lshlrev_b32 v112, 16, v96
    v_and_b32 v96, 0xffff0000, v96
    v_lshlrev_b32 v113, 16, v97
    v_and_b32 v97, 0xffff0000, v97
    v_fmac_f32 v92, v112, v114
    v_fmac_f32 v93, v96, v114
    v_fmac_f32 v94, v113, v114
    v_fmac_f32 v95, v97, v114
    s_waitcnt vmcnt(5)
    s_mov_b64 exec, -1
    v_mfma_f32_4x4x4_16b_bf16 v[108:111], v[122:123], v[28:29], 0
    s_mov_b64 exec, s[44:45]
    v_min_u32 v99, 25, v56
    v_cmp_le_u32 vcc, 25, v56
    v_mad_u32_u24 v99, v99, s89, v78
    s_nop 0
    v_mul_f32 v108, v108, v92
    v_mul_f32 v109, v109, v93
    v_mul_f32 v110, v110, v94
    v_mul_f32 v111, v111, v95
    v_cvt_pk_bf16_f32 v28, v108, v109
    v_cvt_pk_bf16_f32 v29, v110, v111
    ds_write_b64 v99, v[28:29] offset:30288
    s_cbranch_vccz gather_scatter__molecular_angular_gemnet__graph_kernel_noovfS1
    s_mov_b64 exec, vcc
    v_lshlrev_b32 v98, 1, v78
    ds_add_f32 v98, v108 offset:3232
    ds_add_f32 v98, v109 offset:3236
    ds_add_f32 v98, v110 offset:3240
    ds_add_f32 v98, v111 offset:3244
    s_waitcnt lgkmcnt(0)
gather_scatter__molecular_angular_gemnet__graph_kernel_noovfS1:
    s_mov_b64 exec, s[52:53]
    v_lshrrev_b32 v36, 10, v86
    v_and_b32 v86, 0x3ff, v86
    buffer_load_dwordx2 v[36:37], v36, s[8:11], 0 offen
    v_lshlrev_b32 v86, 3, v86
    s_mov_b64 exec, s[50:51]
    v_lshrrev_b32 v117, 1, v84
    ds_add_rtn_u32 v55, v117, v4 offset:0
    s_mov_b64 exec, s[48:49]
    v_lshlrev_b32 v98, 1, v82
    ds_read_b128 v[92:95], v98 offset:13232
    ds_read_b64 v[96:97], v82 offset:23232
    s_mov_b64 exec, s[46:47]
    v_lshlrev_b32 v112, 16, v81
    v_mul_f32 v112, 0.15915494, v112
    v_fract_f32 v112, v112
    v_cos_f32 v112, v112
    s_nop 0
    v_add_f32 v114, v112, v112
    v_fma_f32 v113, v114, v112, -1.0
    v_fma_f32 v114, v114, v113, -v112
    v_cvt_pk_bf16_f32 v115, v112, v113
    v_cvt_pk_bf16_f32 v114, 0, v114
    s_waitcnt lgkmcnt(4)
    v_dot2_f32_bf16 v100, v100, v115, 0
    v_dot2_f32_bf16 v101, v101, v115, 0
    v_dot2_f32_bf16 v102, v102, v115, 0
    v_dot2_f32_bf16 v103, v103, v115, 0
    v_lshlrev_b32 v112, 16, v104
    v_and_b32 v104, 0xffff0000, v104
    v_lshlrev_b32 v113, 16, v105
    v_and_b32 v105, 0xffff0000, v105
    v_fmac_f32 v100, v112, v114
    v_fmac_f32 v101, v104, v114
    v_fmac_f32 v102, v113, v114
    v_fmac_f32 v103, v105, v114
    s_waitcnt vmcnt(5)
    s_mov_b64 exec, -1
    v_mfma_f32_4x4x4_16b_bf16 v[108:111], v[122:123], v[30:31], 0
    s_mov_b64 exec, s[46:47]
    v_min_u32 v107, 25, v57
    v_cmp_le_u32 vcc, 25, v57
    v_mad_u32_u24 v107, v107, s89, v80
    s_nop 0
    v_mul_f32 v108, v108, v100
    v_mul_f32 v109, v109, v101
    v_mul_f32 v110, v110, v102
    v_mul_f32 v111, v111, v103
    v_cvt_pk_bf16_f32 v30, v108, v109
    v_cvt_pk_bf16_f32 v31, v110, v111
    ds_write_b64 v107, v[30:31] offset:30288
    s_cbranch_vccz gather_scatter__molecular_angular_gemnet__graph_kernel_noovfS2
    s_mov_b64 exec, vcc
    v_lshlrev_b32 v106, 1, v80
    ds_add_f32 v106, v108 offset:3232
    ds_add_f32 v106, v109 offset:3236
    ds_add_f32 v106, v110 offset:3240
    ds_add_f32 v106, v111 offset:3244
    s_waitcnt lgkmcnt(0)
gather_scatter__molecular_angular_gemnet__graph_kernel_noovfS2:
    s_mov_b64 exec, s[54:55]
    v_lshrrev_b32 v38, 10, v58
    v_and_b32 v58, 0x3ff, v58
    buffer_load_dwordx2 v[38:39], v38, s[8:11], 0 offen
    v_lshlrev_b32 v58, 3, v58
    s_mov_b64 exec, s[52:53]
    v_lshrrev_b32 v116, 1, v86
    ds_add_rtn_u32 v56, v116, v4 offset:0
    s_mov_b64 exec, s[50:51]
    v_lshlrev_b32 v106, 1, v84
    ds_read_b128 v[100:103], v106 offset:13232
    ds_read_b64 v[104:105], v84 offset:23232
    s_mov_b64 exec, s[48:49]
    v_lshlrev_b32 v112, 16, v83
    v_mul_f32 v112, 0.15915494, v112
    v_fract_f32 v112, v112
    v_cos_f32 v112, v112
    s_nop 0
    v_add_f32 v114, v112, v112
    v_fma_f32 v113, v114, v112, -1.0
    v_fma_f32 v114, v114, v113, -v112
    v_cvt_pk_bf16_f32 v115, v112, v113
    v_cvt_pk_bf16_f32 v114, 0, v114
    s_waitcnt lgkmcnt(4)
    v_dot2_f32_bf16 v92, v92, v115, 0
    v_dot2_f32_bf16 v93, v93, v115, 0
    v_dot2_f32_bf16 v94, v94, v115, 0
    v_dot2_f32_bf16 v95, v95, v115, 0
    v_lshlrev_b32 v112, 16, v96
    v_and_b32 v96, 0xffff0000, v96
    v_lshlrev_b32 v113, 16, v97
    v_and_b32 v97, 0xffff0000, v97
    v_fmac_f32 v92, v112, v114
    v_fmac_f32 v93, v96, v114
    v_fmac_f32 v94, v113, v114
    v_fmac_f32 v95, v97, v114
    s_waitcnt vmcnt(3)
    s_mov_b64 exec, -1
    v_mfma_f32_4x4x4_16b_bf16 v[108:111], v[122:123], v[32:33], 0
    s_mov_b64 exec, s[48:49]
    v_min_u32 v99, 25, v54
    v_cmp_le_u32 vcc, 25, v54
    v_mad_u32_u24 v99, v99, s89, v82
    s_nop 0
    v_mul_f32 v108, v108, v92
    v_mul_f32 v109, v109, v93
    v_mul_f32 v110, v110, v94
    v_mul_f32 v111, v111, v95
    v_cvt_pk_bf16_f32 v32, v108, v109
    v_cvt_pk_bf16_f32 v33, v110, v111
    ds_write_b64 v99, v[32:33] offset:30288
    s_cbranch_vccz gather_scatter__molecular_angular_gemnet__graph_kernel_noovfS3
    s_mov_b64 exec, vcc
    v_lshlrev_b32 v98, 1, v82
    ds_add_f32 v98, v108 offset:3232
    ds_add_f32 v98, v109 offset:3236
    ds_add_f32 v98, v110 offset:3240
    ds_add_f32 v98, v111 offset:3244
    s_waitcnt lgkmcnt(0)
gather_scatter__molecular_angular_gemnet__graph_kernel_noovfS3:
    s_mov_b64 exec, s[56:57]
    v_lshrrev_b32 v40, 10, v60
    v_and_b32 v60, 0x3ff, v60
    buffer_load_dwordx2 v[40:41], v40, s[8:11], 0 offen
    v_lshlrev_b32 v60, 3, v60
    s_mov_b64 exec, s[54:55]
    v_lshrrev_b32 v117, 1, v58
    ds_add_rtn_u32 v57, v117, v4 offset:0
    s_mov_b64 exec, s[52:53]
    v_lshlrev_b32 v98, 1, v86
    ds_read_b128 v[92:95], v98 offset:13232
    ds_read_b64 v[96:97], v86 offset:23232
    s_mov_b64 exec, s[50:51]
    v_lshlrev_b32 v112, 16, v85
    v_mul_f32 v112, 0.15915494, v112
    v_fract_f32 v112, v112
    v_cos_f32 v112, v112
    s_nop 0
    v_add_f32 v114, v112, v112
    v_fma_f32 v113, v114, v112, -1.0
    v_fma_f32 v114, v114, v113, -v112
    v_cvt_pk_bf16_f32 v115, v112, v113
    v_cvt_pk_bf16_f32 v114, 0, v114
    s_waitcnt lgkmcnt(4)
    v_dot2_f32_bf16 v100, v100, v115, 0
    v_dot2_f32_bf16 v101, v101, v115, 0
    v_dot2_f32_bf16 v102, v102, v115, 0
    v_dot2_f32_bf16 v103, v103, v115, 0
    v_lshlrev_b32 v112, 16, v104
    v_and_b32 v104, 0xffff0000, v104
    v_lshlrev_b32 v113, 16, v105
    v_and_b32 v105, 0xffff0000, v105
    v_fmac_f32 v100, v112, v114
    v_fmac_f32 v101, v104, v114
    v_fmac_f32 v102, v113, v114
    v_fmac_f32 v103, v105, v114
    s_waitcnt vmcnt(3)
    s_mov_b64 exec, -1
    v_mfma_f32_4x4x4_16b_bf16 v[108:111], v[122:123], v[34:35], 0
    s_mov_b64 exec, s[50:51]
    v_min_u32 v107, 25, v55
    v_cmp_le_u32 vcc, 25, v55
    v_mad_u32_u24 v107, v107, s89, v84
    s_nop 0
    v_mul_f32 v108, v108, v100
    v_mul_f32 v109, v109, v101
    v_mul_f32 v110, v110, v102
    v_mul_f32 v111, v111, v103
    v_cvt_pk_bf16_f32 v34, v108, v109
    v_cvt_pk_bf16_f32 v35, v110, v111
    ds_write_b64 v107, v[34:35] offset:30288
    s_cbranch_vccz gather_scatter__molecular_angular_gemnet__graph_kernel_noovfS4
    s_mov_b64 exec, vcc
    v_lshlrev_b32 v106, 1, v84
    ds_add_f32 v106, v108 offset:3232
    ds_add_f32 v106, v109 offset:3236
    ds_add_f32 v106, v110 offset:3240
    ds_add_f32 v106, v111 offset:3244
    s_waitcnt lgkmcnt(0)
gather_scatter__molecular_angular_gemnet__graph_kernel_noovfS4:
    s_mov_b64 exec, s[58:59]
    v_lshrrev_b32 v42, 10, v62
    v_and_b32 v62, 0x3ff, v62
    buffer_load_dwordx2 v[42:43], v42, s[8:11], 0 offen
    v_lshlrev_b32 v62, 3, v62
    s_mov_b64 exec, s[64:65]
    v_lshrrev_b32 v48, 10, v88
    v_and_b32 v88, 0x3ff, v88
    buffer_load_dwordx2 v[48:49], v48, s[8:11], 0 offen
    v_lshlrev_b32 v88, 3, v88
    s_mov_b64 exec, s[56:57]
    v_lshrrev_b32 v116, 1, v60
    ds_add_rtn_u32 v54, v116, v4 offset:0
    s_mov_b64 exec, s[54:55]
    v_lshlrev_b32 v106, 1, v58
    ds_read_b128 v[100:103], v106 offset:13232
    ds_read_b64 v[104:105], v58 offset:23232
    s_mov_b64 exec, s[52:53]
    v_lshlrev_b32 v112, 16, v87
    v_mul_f32 v112, 0.15915494, v112
    v_fract_f32 v112, v112
    v_cos_f32 v112, v112
    s_nop 0
    v_add_f32 v114, v112, v112
    v_fma_f32 v113, v114, v112, -1.0
    v_fma_f32 v114, v114, v113, -v112
    v_cvt_pk_bf16_f32 v115, v112, v113
    v_cvt_pk_bf16_f32 v114, 0, v114
    s_waitcnt lgkmcnt(4)
    v_dot2_f32_bf16 v92, v92, v115, 0
    v_dot2_f32_bf16 v93, v93, v115, 0
    v_dot2_f32_bf16 v94, v94, v115, 0
    v_dot2_f32_bf16 v95, v95, v115, 0
    v_lshlrev_b32 v112, 16, v96
    v_and_b32 v96, 0xffff0000, v96
    v_lshlrev_b32 v113, 16, v97
    v_and_b32 v97, 0xffff0000, v97
    v_fmac_f32 v92, v112, v114
    v_fmac_f32 v93, v96, v114
    v_fmac_f32 v94, v113, v114
    v_fmac_f32 v95, v97, v114
    s_waitcnt vmcnt(4)
    s_mov_b64 exec, -1
    v_mfma_f32_4x4x4_16b_bf16 v[108:111], v[122:123], v[36:37], 0
    s_mov_b64 exec, s[52:53]
    v_min_u32 v99, 25, v56
    v_cmp_le_u32 vcc, 25, v56
    v_mad_u32_u24 v99, v99, s89, v86
    s_nop 0
    v_mul_f32 v108, v108, v92
    v_mul_f32 v109, v109, v93
    v_mul_f32 v110, v110, v94
    v_mul_f32 v111, v111, v95
    v_cvt_pk_bf16_f32 v36, v108, v109
    v_cvt_pk_bf16_f32 v37, v110, v111
    ds_write_b64 v99, v[36:37] offset:30288
    s_cbranch_vccz gather_scatter__molecular_angular_gemnet__graph_kernel_noovfS5
    s_mov_b64 exec, vcc
    v_lshlrev_b32 v98, 1, v86
    ds_add_f32 v98, v108 offset:3232
    ds_add_f32 v98, v109 offset:3236
    ds_add_f32 v98, v110 offset:3240
    ds_add_f32 v98, v111 offset:3244
    s_waitcnt lgkmcnt(0)
gather_scatter__molecular_angular_gemnet__graph_kernel_noovfS5:
    s_mov_b64 exec, s[60:61]
    v_lshrrev_b32 v44, 10, v64
    v_and_b32 v64, 0x3ff, v64
    buffer_load_dwordx2 v[44:45], v44, s[8:11], 0 offen
    v_lshlrev_b32 v64, 3, v64
    s_mov_b64 exec, s[66:67]
    v_lshrrev_b32 v50, 10, v90
    v_and_b32 v90, 0x3ff, v90
    buffer_load_dwordx2 v[50:51], v50, s[8:11], 0 offen
    v_lshlrev_b32 v90, 3, v90
    s_mov_b64 exec, s[66:67]
    v_lshrrev_b32 v117, 1, v90
    ds_add_rtn_u32 v23, v117, v4 offset:0
    s_mov_b64 exec, s[58:59]
    v_lshrrev_b32 v117, 1, v62
    ds_add_rtn_u32 v55, v117, v4 offset:0
    s_mov_b64 exec, s[56:57]
    v_lshlrev_b32 v98, 1, v60
    ds_read_b128 v[92:95], v98 offset:13232
    ds_read_b64 v[96:97], v60 offset:23232
    s_mov_b64 exec, s[54:55]
    v_lshlrev_b32 v112, 16, v59
    v_mul_f32 v112, 0.15915494, v112
    v_fract_f32 v112, v112
    v_cos_f32 v112, v112
    s_nop 0
    v_add_f32 v114, v112, v112
    v_fma_f32 v113, v114, v112, -1.0
    v_fma_f32 v114, v114, v113, -v112
    v_cvt_pk_bf16_f32 v115, v112, v113
    v_cvt_pk_bf16_f32 v114, 0, v114
    s_waitcnt lgkmcnt(5)
    v_dot2_f32_bf16 v100, v100, v115, 0
    v_dot2_f32_bf16 v101, v101, v115, 0
    v_dot2_f32_bf16 v102, v102, v115, 0
    v_dot2_f32_bf16 v103, v103, v115, 0
    v_lshlrev_b32 v112, 16, v104
    v_and_b32 v104, 0xffff0000, v104
    v_lshlrev_b32 v113, 16, v105
    v_and_b32 v105, 0xffff0000, v105
    v_fmac_f32 v100, v112, v114
    v_fmac_f32 v101, v104, v114
    v_fmac_f32 v102, v113, v114
    v_fmac_f32 v103, v105, v114
    s_waitcnt vmcnt(5)
    s_mov_b64 exec, -1
    v_mfma_f32_4x4x4_16b_bf16 v[108:111], v[122:123], v[38:39], 0
    s_mov_b64 exec, s[54:55]
    v_min_u32 v107, 25, v57
    v_cmp_le_u32 vcc, 25, v57
    v_mad_u32_u24 v107, v107, s89, v58
    s_nop 0
    v_mul_f32 v108, v108, v100
    v_mul_f32 v109, v109, v101
    v_mul_f32 v110, v110, v102
    v_mul_f32 v111, v111, v103
    v_cvt_pk_bf16_f32 v38, v108, v109
    v_cvt_pk_bf16_f32 v39, v110, v111
    ds_write_b64 v107, v[38:39] offset:30288
    s_cbranch_vccz gather_scatter__molecular_angular_gemnet__graph_kernel_noovfS6
    s_mov_b64 exec, vcc
    v_lshlrev_b32 v106, 1, v58
    ds_add_f32 v106, v108 offset:3232
    ds_add_f32 v106, v109 offset:3236
    ds_add_f32 v106, v110 offset:3240
    ds_add_f32 v106, v111 offset:3244
    s_waitcnt lgkmcnt(0)
gather_scatter__molecular_angular_gemnet__graph_kernel_noovfS6:
    s_mov_b64 exec, s[62:63]
    v_lshrrev_b32 v46, 10, v66
    v_and_b32 v66, 0x3ff, v66
    buffer_load_dwordx2 v[46:47], v46, s[8:11], 0 offen
    v_lshlrev_b32 v66, 3, v66
    s_mov_b64 exec, s[60:61]
    v_lshrrev_b32 v116, 1, v64
    ds_add_rtn_u32 v56, v116, v4 offset:0
    s_mov_b64 exec, s[58:59]
    v_lshlrev_b32 v106, 1, v62
    ds_read_b128 v[100:103], v106 offset:13232
    ds_read_b64 v[104:105], v62 offset:23232
    s_mov_b64 exec, s[56:57]
    v_lshlrev_b32 v112, 16, v61
    v_mul_f32 v112, 0.15915494, v112
    v_fract_f32 v112, v112
    v_cos_f32 v112, v112
    s_nop 0
    v_add_f32 v114, v112, v112
    v_fma_f32 v113, v114, v112, -1.0
    v_fma_f32 v114, v114, v113, -v112
    v_cvt_pk_bf16_f32 v115, v112, v113
    v_cvt_pk_bf16_f32 v114, 0, v114
    s_waitcnt lgkmcnt(4)
    v_dot2_f32_bf16 v92, v92, v115, 0
    v_dot2_f32_bf16 v93, v93, v115, 0
    v_dot2_f32_bf16 v94, v94, v115, 0
    v_dot2_f32_bf16 v95, v95, v115, 0
    v_lshlrev_b32 v112, 16, v96
    v_and_b32 v96, 0xffff0000, v96
    v_lshlrev_b32 v113, 16, v97
    v_and_b32 v97, 0xffff0000, v97
    v_fmac_f32 v92, v112, v114
    v_fmac_f32 v93, v96, v114
    v_fmac_f32 v94, v113, v114
    v_fmac_f32 v95, v97, v114
    s_waitcnt vmcnt(5)
    s_mov_b64 exec, -1
    v_mfma_f32_4x4x4_16b_bf16 v[108:111], v[122:123], v[40:41], 0
    s_mov_b64 exec, s[56:57]
    v_min_u32 v99, 25, v54
    v_cmp_le_u32 vcc, 25, v54
    v_mad_u32_u24 v99, v99, s89, v60
    s_nop 0
    v_mul_f32 v108, v108, v92
    v_mul_f32 v109, v109, v93
    v_mul_f32 v110, v110, v94
    v_mul_f32 v111, v111, v95
    v_cvt_pk_bf16_f32 v40, v108, v109
    v_cvt_pk_bf16_f32 v41, v110, v111
    ds_write_b64 v99, v[40:41] offset:30288
    s_cbranch_vccz gather_scatter__molecular_angular_gemnet__graph_kernel_noovfS7
    s_mov_b64 exec, vcc
    v_lshlrev_b32 v98, 1, v60
    ds_add_f32 v98, v108 offset:3232
    ds_add_f32 v98, v109 offset:3236
    ds_add_f32 v98, v110 offset:3240
    ds_add_f32 v98, v111 offset:3244
    s_waitcnt lgkmcnt(0)
gather_scatter__molecular_angular_gemnet__graph_kernel_noovfS7:
    s_mov_b64 exec, s[62:63]
    v_lshrrev_b32 v117, 1, v66
    ds_add_rtn_u32 v57, v117, v4 offset:0
    s_mov_b64 exec, s[60:61]
    v_lshlrev_b32 v98, 1, v64
    ds_read_b128 v[92:95], v98 offset:13232
    ds_read_b64 v[96:97], v64 offset:23232
    s_mov_b64 exec, s[58:59]
    v_lshlrev_b32 v112, 16, v63
    v_mul_f32 v112, 0.15915494, v112
    v_fract_f32 v112, v112
    v_cos_f32 v112, v112
    s_nop 0
    v_add_f32 v114, v112, v112
    v_fma_f32 v113, v114, v112, -1.0
    v_fma_f32 v114, v114, v113, -v112
    v_cvt_pk_bf16_f32 v115, v112, v113
    v_cvt_pk_bf16_f32 v114, 0, v114
    s_waitcnt lgkmcnt(4)
    v_dot2_f32_bf16 v100, v100, v115, 0
    v_dot2_f32_bf16 v101, v101, v115, 0
    v_dot2_f32_bf16 v102, v102, v115, 0
    v_dot2_f32_bf16 v103, v103, v115, 0
    v_lshlrev_b32 v112, 16, v104
    v_and_b32 v104, 0xffff0000, v104
    v_lshlrev_b32 v113, 16, v105
    v_and_b32 v105, 0xffff0000, v105
    v_fmac_f32 v100, v112, v114
    v_fmac_f32 v101, v104, v114
    v_fmac_f32 v102, v113, v114
    v_fmac_f32 v103, v105, v114
    s_waitcnt vmcnt(4)
    s_mov_b64 exec, -1
    v_mfma_f32_4x4x4_16b_bf16 v[108:111], v[122:123], v[42:43], 0
    s_mov_b64 exec, s[58:59]
    v_min_u32 v107, 25, v55
    v_cmp_le_u32 vcc, 25, v55
    v_mad_u32_u24 v107, v107, s89, v62
    s_nop 0
    v_mul_f32 v108, v108, v100
    v_mul_f32 v109, v109, v101
    v_mul_f32 v110, v110, v102
    v_mul_f32 v111, v111, v103
    v_cvt_pk_bf16_f32 v42, v108, v109
    v_cvt_pk_bf16_f32 v43, v110, v111
    ds_write_b64 v107, v[42:43] offset:30288
    s_cbranch_vccz gather_scatter__molecular_angular_gemnet__graph_kernel_noovfS8
    s_mov_b64 exec, vcc
    v_lshlrev_b32 v106, 1, v62
    ds_add_f32 v106, v108 offset:3232
    ds_add_f32 v106, v109 offset:3236
    ds_add_f32 v106, v110 offset:3240
    ds_add_f32 v106, v111 offset:3244
    s_waitcnt lgkmcnt(0)
gather_scatter__molecular_angular_gemnet__graph_kernel_noovfS8:
    s_mov_b64 exec, s[64:65]
    v_lshrrev_b32 v116, 1, v88
    ds_add_rtn_u32 v54, v116, v4 offset:0
    s_mov_b64 exec, s[62:63]
    v_lshlrev_b32 v106, 1, v66
    ds_read_b128 v[100:103], v106 offset:13232
    ds_read_b64 v[104:105], v66 offset:23232
    s_mov_b64 exec, s[60:61]
    v_lshlrev_b32 v112, 16, v65
    v_mul_f32 v112, 0.15915494, v112
    v_fract_f32 v112, v112
    v_cos_f32 v112, v112
    s_nop 0
    v_add_f32 v114, v112, v112
    v_fma_f32 v113, v114, v112, -1.0
    v_fma_f32 v114, v114, v113, -v112
    v_cvt_pk_bf16_f32 v115, v112, v113
    v_cvt_pk_bf16_f32 v114, 0, v114
    s_waitcnt lgkmcnt(4)
    v_dot2_f32_bf16 v92, v92, v115, 0
    v_dot2_f32_bf16 v93, v93, v115, 0
    v_dot2_f32_bf16 v94, v94, v115, 0
    v_dot2_f32_bf16 v95, v95, v115, 0
    v_lshlrev_b32 v112, 16, v96
    v_and_b32 v96, 0xffff0000, v96
    v_lshlrev_b32 v113, 16, v97
    v_and_b32 v97, 0xffff0000, v97
    v_fmac_f32 v92, v112, v114
    v_fmac_f32 v93, v96, v114
    v_fmac_f32 v94, v113, v114
    v_fmac_f32 v95, v97, v114
    s_waitcnt vmcnt(2)
    s_mov_b64 exec, -1
    v_mfma_f32_4x4x4_16b_bf16 v[108:111], v[122:123], v[44:45], 0
    s_mov_b64 exec, s[60:61]
    v_min_u32 v99, 25, v56
    v_cmp_le_u32 vcc, 25, v56
    v_mad_u32_u24 v99, v99, s89, v64
    s_nop 0
    v_mul_f32 v108, v108, v92
    v_mul_f32 v109, v109, v93
    v_mul_f32 v110, v110, v94
    v_mul_f32 v111, v111, v95
    v_cvt_pk_bf16_f32 v44, v108, v109
    v_cvt_pk_bf16_f32 v45, v110, v111
    ds_write_b64 v99, v[44:45] offset:30288
    s_cbranch_vccz gather_scatter__molecular_angular_gemnet__graph_kernel_noovfS9
    s_mov_b64 exec, vcc
    v_lshlrev_b32 v98, 1, v64
    ds_add_f32 v98, v108 offset:3232
    ds_add_f32 v98, v109 offset:3236
    ds_add_f32 v98, v110 offset:3240
    ds_add_f32 v98, v111 offset:3244
    s_waitcnt lgkmcnt(0)
gather_scatter__molecular_angular_gemnet__graph_kernel_noovfS9:
    s_mov_b64 exec, s[64:65]
    v_lshlrev_b32 v98, 1, v88
    ds_read_b128 v[92:95], v98 offset:13232
    ds_read_b64 v[96:97], v88 offset:23232
    s_mov_b64 exec, s[62:63]
    v_lshlrev_b32 v112, 16, v67
    v_mul_f32 v112, 0.15915494, v112
    v_fract_f32 v112, v112
    v_cos_f32 v112, v112
    s_nop 0
    v_add_f32 v114, v112, v112
    v_fma_f32 v113, v114, v112, -1.0
    v_fma_f32 v114, v114, v113, -v112
    v_cvt_pk_bf16_f32 v115, v112, v113
    v_cvt_pk_bf16_f32 v114, 0, v114
    s_waitcnt lgkmcnt(3)
    v_dot2_f32_bf16 v100, v100, v115, 0
    v_dot2_f32_bf16 v101, v101, v115, 0
    v_dot2_f32_bf16 v102, v102, v115, 0
    v_dot2_f32_bf16 v103, v103, v115, 0
    v_lshlrev_b32 v112, 16, v104
    v_and_b32 v104, 0xffff0000, v104
    v_lshlrev_b32 v113, 16, v105
    v_and_b32 v105, 0xffff0000, v105
    v_fmac_f32 v100, v112, v114
    v_fmac_f32 v101, v104, v114
    v_fmac_f32 v102, v113, v114
    v_fmac_f32 v103, v105, v114
    s_waitcnt vmcnt(0)
    s_mov_b64 exec, -1
    v_mfma_f32_4x4x4_16b_bf16 v[108:111], v[122:123], v[46:47], 0
    s_mov_b64 exec, s[62:63]
    v_min_u32 v107, 25, v57
    v_cmp_le_u32 vcc, 25, v57
    v_mad_u32_u24 v107, v107, s89, v66
    s_nop 0
    v_mul_f32 v108, v108, v100
    v_mul_f32 v109, v109, v101
    v_mul_f32 v110, v110, v102
    v_mul_f32 v111, v111, v103
    v_cvt_pk_bf16_f32 v46, v108, v109
    v_cvt_pk_bf16_f32 v47, v110, v111
    ds_write_b64 v107, v[46:47] offset:30288
    s_cbranch_vccz gather_scatter__molecular_angular_gemnet__graph_kernel_noovfS10
    s_mov_b64 exec, vcc
    v_lshlrev_b32 v106, 1, v66
    ds_add_f32 v106, v108 offset:3232
    ds_add_f32 v106, v109 offset:3236
    ds_add_f32 v106, v110 offset:3240
    ds_add_f32 v106, v111 offset:3244
    s_waitcnt lgkmcnt(0)
gather_scatter__molecular_angular_gemnet__graph_kernel_noovfS10:
    s_mov_b64 exec, s[64:65]
    v_lshlrev_b32 v112, 16, v89
    v_mul_f32 v112, 0.15915494, v112
    v_fract_f32 v112, v112
    v_cos_f32 v112, v112
    s_nop 0
    v_add_f32 v114, v112, v112
    v_fma_f32 v113, v114, v112, -1.0
    v_fma_f32 v114, v114, v113, -v112
    v_cvt_pk_bf16_f32 v115, v112, v113
    v_cvt_pk_bf16_f32 v114, 0, v114
    s_waitcnt lgkmcnt(1)
    v_dot2_f32_bf16 v92, v92, v115, 0
    v_dot2_f32_bf16 v93, v93, v115, 0
    v_dot2_f32_bf16 v94, v94, v115, 0
    v_dot2_f32_bf16 v95, v95, v115, 0
    v_lshlrev_b32 v112, 16, v96
    v_and_b32 v96, 0xffff0000, v96
    v_lshlrev_b32 v113, 16, v97
    v_and_b32 v97, 0xffff0000, v97
    v_fmac_f32 v92, v112, v114
    v_fmac_f32 v93, v96, v114
    v_fmac_f32 v94, v113, v114
    v_fmac_f32 v95, v97, v114
    s_mov_b64 exec, -1
    v_mfma_f32_4x4x4_16b_bf16 v[108:111], v[122:123], v[48:49], 0
    s_mov_b64 exec, s[64:65]
    v_min_u32 v99, 25, v54
    v_cmp_le_u32 vcc, 25, v54
    v_mad_u32_u24 v99, v99, s89, v88
    s_nop 0
    v_mul_f32 v108, v108, v92
    v_mul_f32 v109, v109, v93
    v_mul_f32 v110, v110, v94
    v_mul_f32 v111, v111, v95
    v_cvt_pk_bf16_f32 v48, v108, v109
    v_cvt_pk_bf16_f32 v49, v110, v111
    ds_write_b64 v99, v[48:49] offset:30288
    s_cbranch_vccz gather_scatter__molecular_angular_gemnet__graph_kernel_noovfT0
    s_mov_b64 exec, vcc
    v_lshlrev_b32 v98, 1, v88
    ds_add_f32 v98, v108 offset:3232
    ds_add_f32 v98, v109 offset:3236
    ds_add_f32 v98, v110 offset:3240
    ds_add_f32 v98, v111 offset:3244
    s_waitcnt lgkmcnt(0)
gather_scatter__molecular_angular_gemnet__graph_kernel_noovfT0:
    s_cmp_eq_u64 s[66:67], 0
    s_cbranch_scc1 gather_scatter__molecular_angular_gemnet__graph_kernel_sdone
    s_mov_b64 exec, s[66:67]
    v_lshlrev_b32 v106, 1, v90
    ds_read_b128 v[100:103], v106 offset:13232
    ds_read_b64 v[104:105], v90 offset:23232
    s_mov_b64 exec, s[66:67]
    v_lshlrev_b32 v112, 16, v91
    v_mul_f32 v112, 0.15915494, v112
    v_fract_f32 v112, v112
    v_cos_f32 v112, v112
    s_nop 0
    v_add_f32 v114, v112, v112
    v_fma_f32 v113, v114, v112, -1.0
    v_fma_f32 v114, v114, v113, -v112
    v_cvt_pk_bf16_f32 v115, v112, v113
    v_cvt_pk_bf16_f32 v114, 0, v114
    s_waitcnt lgkmcnt(0)
    v_dot2_f32_bf16 v100, v100, v115, 0
    v_dot2_f32_bf16 v101, v101, v115, 0
    v_dot2_f32_bf16 v102, v102, v115, 0
    v_dot2_f32_bf16 v103, v103, v115, 0
    v_lshlrev_b32 v112, 16, v104
    v_and_b32 v104, 0xffff0000, v104
    v_lshlrev_b32 v113, 16, v105
    v_and_b32 v105, 0xffff0000, v105
    v_fmac_f32 v100, v112, v114
    v_fmac_f32 v101, v104, v114
    v_fmac_f32 v102, v113, v114
    v_fmac_f32 v103, v105, v114
    s_mov_b64 exec, -1
    v_mfma_f32_4x4x4_16b_bf16 v[108:111], v[122:123], v[50:51], 0
    s_mov_b64 exec, s[66:67]
    v_min_u32 v107, 25, v23
    v_cmp_le_u32 vcc, 25, v23
    v_mad_u32_u24 v107, v107, s89, v90
    s_nop 0
    v_mul_f32 v108, v108, v100
    v_mul_f32 v109, v109, v101
    v_mul_f32 v110, v110, v102
    v_mul_f32 v111, v111, v103
    v_cvt_pk_bf16_f32 v50, v108, v109
    v_cvt_pk_bf16_f32 v51, v110, v111
    ds_write_b64 v107, v[50:51] offset:30288
    s_cbranch_vccz gather_scatter__molecular_angular_gemnet__graph_kernel_noovfT1
    s_mov_b64 exec, vcc
    v_lshlrev_b32 v106, 1, v90
    ds_add_f32 v106, v108 offset:3232
    ds_add_f32 v106, v109 offset:3236
    ds_add_f32 v106, v110 offset:3240
    ds_add_f32 v106, v111 offset:3244
    s_waitcnt lgkmcnt(0)
gather_scatter__molecular_angular_gemnet__graph_kernel_noovfT1:
gather_scatter__molecular_angular_gemnet__graph_kernel_sdone:
    s_mov_b64 exec, -1
    v_mov_b32 v112, 2560
    v_add_u32 v114, 0x7650, v5
    s_waitcnt lgkmcnt(0)
    s_waitcnt vmcnt(0)
    s_barrier
    ds_read_b32 v113, v112
    s_cmp_ge_u32 s32, 10
    s_cbranch_scc1 gather_scatter__molecular_angular_gemnet__graph_kernel_nored
    ds_read2st64_b64 v[24:27], v114 offset0:0 offset1:10
    ds_read2st64_b64 v[28:31], v114 offset0:20 offset1:30
    ds_read2st64_b64 v[32:35], v114 offset0:40 offset1:50
    ds_read2st64_b64 v[36:39], v114 offset0:60 offset1:70
    ds_read2st64_b64 v[40:43], v114 offset0:80 offset1:90
    ds_read2st64_b64 v[44:47], v114 offset0:100 offset1:110
    ds_read2st64_b64 v[48:51], v114 offset0:120 offset1:130
    ds_read2st64_b64 v[52:55], v114 offset0:140 offset1:150
    ds_read2st64_b64 v[56:59], v114 offset0:160 offset1:170
    ds_read2st64_b64 v[60:63], v114 offset0:180 offset1:190
    ds_read2st64_b64 v[64:67], v114 offset0:200 offset1:210
    ds_read2st64_b64 v[68:71], v114 offset0:220 offset1:230
    ds_read2st64_b64 v[72:75], v114 offset0:240 offset1:250
    s_waitcnt lgkmcnt(12)
    v_mfma_f32_4x4x4_16b_bf16 v[92:95], v[2:3], v[24:25], v[10:13]
    v_mfma_f32_4x4x4_16b_bf16 v[96:99], v[2:3], v[26:27], 0
    s_waitcnt lgkmcnt(11)
    v_mfma_f32_4x4x4_16b_bf16 v[100:103], v[2:3], v[28:29], 0
    v_mfma_f32_4x4x4_16b_bf16 v[104:107], v[2:3], v[30:31], 0
    s_waitcnt lgkmcnt(10)
    v_mfma_f32_4x4x4_16b_bf16 v[92:95], v[2:3], v[32:33], v[92:95]
    v_mfma_f32_4x4x4_16b_bf16 v[96:99], v[2:3], v[34:35], v[96:99]
    s_waitcnt lgkmcnt(9)
    v_mfma_f32_4x4x4_16b_bf16 v[100:103], v[2:3], v[36:37], v[100:103]
    v_mfma_f32_4x4x4_16b_bf16 v[104:107], v[2:3], v[38:39], v[104:107]
    s_waitcnt lgkmcnt(8)
    v_mfma_f32_4x4x4_16b_bf16 v[92:95], v[2:3], v[40:41], v[92:95]
    v_mfma_f32_4x4x4_16b_bf16 v[96:99], v[2:3], v[42:43], v[96:99]
    s_waitcnt lgkmcnt(7)
    v_mfma_f32_4x4x4_16b_bf16 v[100:103], v[2:3], v[44:45], v[100:103]
    v_mfma_f32_4x4x4_16b_bf16 v[104:107], v[2:3], v[46:47], v[104:107]
    s_waitcnt lgkmcnt(6)
    v_mfma_f32_4x4x4_16b_bf16 v[92:95], v[2:3], v[48:49], v[92:95]
    v_mfma_f32_4x4x4_16b_bf16 v[96:99], v[2:3], v[50:51], v[96:99]
    s_waitcnt lgkmcnt(5)
    v_mfma_f32_4x4x4_16b_bf16 v[100:103], v[2:3], v[52:53], v[100:103]
    v_mfma_f32_4x4x4_16b_bf16 v[104:107], v[2:3], v[54:55], v[104:107]
    s_waitcnt lgkmcnt(4)
    v_mfma_f32_4x4x4_16b_bf16 v[92:95], v[2:3], v[56:57], v[92:95]
    v_mfma_f32_4x4x4_16b_bf16 v[96:99], v[2:3], v[58:59], v[96:99]
    s_waitcnt lgkmcnt(3)
    v_mfma_f32_4x4x4_16b_bf16 v[100:103], v[2:3], v[60:61], v[100:103]
    v_mfma_f32_4x4x4_16b_bf16 v[104:107], v[2:3], v[62:63], v[104:107]
    s_waitcnt lgkmcnt(2)
    v_mfma_f32_4x4x4_16b_bf16 v[92:95], v[2:3], v[64:65], v[92:95]
    v_mfma_f32_4x4x4_16b_bf16 v[96:99], v[2:3], v[66:67], v[96:99]
    s_waitcnt lgkmcnt(1)
    v_mfma_f32_4x4x4_16b_bf16 v[100:103], v[2:3], v[68:69], v[100:103]
    v_mfma_f32_4x4x4_16b_bf16 v[104:107], v[2:3], v[70:71], v[104:107]
    s_waitcnt lgkmcnt(0)
    v_mfma_f32_4x4x4_16b_bf16 v[92:95], v[2:3], v[72:73], v[92:95]
    s_nop 4
    v_pk_add_f32 v[96:97], v[96:97], v[100:101]
    v_pk_add_f32 v[98:99], v[98:99], v[102:103]
    v_pk_add_f32 v[92:93], v[92:93], v[104:105]
    v_pk_add_f32 v[94:95], v[94:95], v[106:107]
    v_pk_add_f32 v[10:11], v[92:93], v[96:97]
    v_pk_add_f32 v[12:13], v[94:95], v[98:99]
gather_scatter__molecular_angular_gemnet__graph_kernel_nored:
    s_waitcnt lgkmcnt(0)
    v_readfirstlane_b32 s39, v113
    s_add_u32 s34, s34, 128
    s_cmp_lg_u32 s39, s34
    s_cbranch_scc1 gather_scatter__molecular_angular_gemnet__graph_kernel_final
gather_scatter__molecular_angular_gemnet__graph_kernel_round:
    s_waitcnt vmcnt(0)
    s_barrier
    v_mov_b32 v116, 0
    v_mov_b32 v117, 0
    v_mov_b32 v118, 0
    v_mov_b32 v119, 0
    v_lshlrev_b32 v112, 4, v0
    v_cmp_gt_u32 vcc, 640, v0
    s_mov_b64 exec, vcc
    ds_write_b32 v22, v116 offset:0
    s_mov_b64 exec, -1
    v_add_u32 v110, 0x7650, v112
    v_add_u32 v111, 0x17650, v112
    ds_write_b128 v110, v[116:119] offset:0
    ds_write_b128 v110, v[116:119] offset:16384
    ds_write_b128 v110, v[116:119] offset:32768
    ds_write_b128 v110, v[116:119] offset:49152
    ds_write_b128 v111, v[116:119] offset:0
    ds_write_b128 v111, v[116:119] offset:16384
    ds_write_b128 v111, v[116:119] offset:32768
    ds_write_b128 v111, v[116:119] offset:49152
    s_add_u32 s37, s34, 128
    v_sub_u32 v108, s34, v16
    v_sub_u32 v109, s37, v16
    v_max_i32 v108, 0, v108
    v_min_i32 v109, v109, v15
    v_add_u32 v108, v108, v18
    v_add_u32 v110, v108, v16
    v_subrev_u32 v110, s34, v110
    v_lshl_add_u32 v110, s32, 7, v110
    s_sub_u32 s36, s35, s34
    s_min_i32 s36, s36, 128
gather_scatter__molecular_angular_gemnet__graph_kernel_lloopb:
    v_cmpx_lt_i32 vcc, v108, v109
    s_cbranch_execz gather_scatter__molecular_angular_gemnet__graph_kernel_ldoneb
    ds_write_b8 v110, v19 offset:28240
    v_add_u32 v108, 4, v108
    v_add_u32 v110, 4, v110
    s_branch gather_scatter__molecular_angular_gemnet__graph_kernel_lloopb
gather_scatter__molecular_angular_gemnet__graph_kernel_ldoneb:
    s_mov_b64 exec, -1
    ds_read_u8 v88, v14 offset:28240
    ds_read_u8 v90, v14 offset:28304
    s_sub_i32 s37, s36, 0
    v_cmp_gt_i32_e64 s[64:65], s37, v1
    s_sub_i32 s37, s36, 64
    v_cmp_gt_i32_e64 s[66:67], s37, v1
    v_add_u32 v111, s34, v1
    s_waitcnt lgkmcnt(0)
    ds_bpermute_b32 v88, v88, v17
    ds_bpermute_b32 v90, v90, v17
    s_waitcnt lgkmcnt(0)
    v_add_lshl_u32 v88, v88, v111, 3
    v_add_lshl_u32 v90, v90, v111, 3
    s_mov_b64 exec, s[64:65]
    buffer_load_dwordx2 v[88:89], v88, s[4:7], s88 offen offset:0
    s_mov_b64 exec, s[66:67]
    buffer_load_dwordx2 v[90:91], v90, s[4:7], s88 offen offset:512
    s_mov_b64 exec, -1
    s_waitcnt lgkmcnt(0)
    s_barrier
    s_add_u32 s37, s34, 128
    s_cmp_gt_u32 s35, s37
    s_cbranch_scc0 gather_scatter__molecular_angular_gemnet__graph_kernel_nomoreb
    v_mov_b32 v112, 2560
    v_mov_b32 v113, s37
    ds_write_b32 v112, v113
gather_scatter__molecular_angular_gemnet__graph_kernel_nomoreb:
    s_waitcnt vmcnt(1)
    s_mov_b64 exec, s[64:65]
    v_lshrrev_b32 v48, 10, v88
    v_and_b32 v88, 0x3ff, v88
    buffer_load_dwordx2 v[48:49], v48, s[8:11], 0 offen
    v_lshlrev_b32 v88, 3, v88
    s_mov_b64 exec, s[64:65]
    v_lshrrev_b32 v116, 1, v88
    ds_add_rtn_u32 v54, v116, v4 offset:0
    s_waitcnt vmcnt(1)
    s_mov_b64 exec, s[66:67]
    v_lshrrev_b32 v50, 10, v90
    v_and_b32 v90, 0x3ff, v90
    buffer_load_dwordx2 v[50:51], v50, s[8:11], 0 offen
    v_lshlrev_b32 v90, 3, v90
    s_mov_b64 exec, s[66:67]
    v_lshrrev_b32 v117, 1, v90
    ds_add_rtn_u32 v23, v117, v4 offset:0
    s_mov_b64 exec, s[64:65]
    v_lshlrev_b32 v98, 1, v88
    ds_read_b128 v[92:95], v98 offset:13232
    ds_read_b64 v[96:97], v88 offset:23232
    s_mov_b64 exec, s[64:65]
    v_lshlrev_b32 v112, 16, v89
    v_mul_f32 v112, 0.15915494, v112
    v_fract_f32 v112, v112
    v_cos_f32 v112, v112
    s_nop 0
    v_add_f32 v114, v112, v112
    v_fma_f32 v113, v114, v112, -1.0
    v_fma_f32 v114, v114, v113, -v112
    v_cvt_pk_bf16_f32 v115, v112, v113
    v_cvt_pk_bf16_f32 v114, 0, v114
    s_waitcnt lgkmcnt(3)
    s_waitcnt lgkmcnt(0)
    v_dot2_f32_bf16 v92, v92, v115, 0
    v_dot2_f32_bf16 v93, v93, v115, 0
    v_dot2_f32_bf16 v94, v94, v115, 0
    v_dot2_f32_bf16 v95, v95, v115, 0
    v_lshlrev_b32 v112, 16, v96
    v_and_b32 v96, 0xffff0000, v96
    v_lshlrev_b32 v113, 16, v97
    v_and_b32 v97, 0xffff0000, v97
    v_fmac_f32 v92, v112, v114
    v_fmac_f32 v93, v96, v114
    v_fmac_f32 v94, v113, v114
    v_fmac_f32 v95, v97, v114
    s_waitcnt vmcnt(1)
    s_mov_b64 exec, -1
    v_mfma_f32_4x4x4_16b_bf16 v[108:111], v[122:123], v[48:49], 0
    s_mov_b64 exec, s[64:65]
    v_min_u32 v99, 25, v54
    v_cmp_le_u32 vcc, 25, v54
    v_mad_u32_u24 v99, v99, s89, v88
    s_nop 0
    v_mul_f32 v108, v108, v92
    v_mul_f32 v109, v109, v93
    v_mul_f32 v110, v110, v94
    v_mul_f32 v111, v111, v95
    v_cvt_pk_bf16_f32 v48, v108, v109
    v_cvt_pk_bf16_f32 v49, v110, v111
    ds_write_b64 v99, v[48:49] offset:30288
    s_cbranch_vccz gather_scatter__molecular_angular_gemnet__graph_kernel_noovfT0b
    s_mov_b64 exec, vcc
    v_lshlrev_b32 v98, 1, v88
    ds_add_f32 v98, v108 offset:3232
    ds_add_f32 v98, v109 offset:3236
    ds_add_f32 v98, v110 offset:3240
    ds_add_f32 v98, v111 offset:3244
    s_waitcnt lgkmcnt(0)
gather_scatter__molecular_angular_gemnet__graph_kernel_noovfT0b:
    s_mov_b64 exec, s[66:67]
    v_lshlrev_b32 v106, 1, v90
    ds_read_b128 v[100:103], v106 offset:13232
    ds_read_b64 v[104:105], v90 offset:23232
    s_mov_b64 exec, s[66:67]
    v_lshlrev_b32 v112, 16, v91
    v_mul_f32 v112, 0.15915494, v112
    v_fract_f32 v112, v112
    v_cos_f32 v112, v112
    s_nop 0
    v_add_f32 v114, v112, v112
    v_fma_f32 v113, v114, v112, -1.0
    v_fma_f32 v114, v114, v113, -v112
    v_cvt_pk_bf16_f32 v115, v112, v113
    v_cvt_pk_bf16_f32 v114, 0, v114
    s_waitcnt lgkmcnt(0)
    v_dot2_f32_bf16 v100, v100, v115, 0
    v_dot2_f32_bf16 v101, v101, v115, 0
    v_dot2_f32_bf16 v102, v102, v115, 0
    v_dot2_f32_bf16 v103, v103, v115, 0
    v_lshlrev_b32 v112, 16, v104
    v_and_b32 v104, 0xffff0000, v104
    v_lshlrev_b32 v113, 16, v105
    v_and_b32 v105, 0xffff0000, v105
    v_fmac_f32 v100, v112, v114
    v_fmac_f32 v101, v104, v114
    v_fmac_f32 v102, v113, v114
    v_fmac_f32 v103, v105, v114
    s_waitcnt vmcnt(0)
    s_mov_b64 exec, -1
    v_mfma_f32_4x4x4_16b_bf16 v[108:111], v[122:123], v[50:51], 0
    s_mov_b64 exec, s[66:67]
    v_min_u32 v107, 25, v23
    v_cmp_le_u32 vcc, 25, v23
    v_mad_u32_u24 v107, v107, s89, v90
    s_nop 0
    v_mul_f32 v108, v108, v100
    v_mul_f32 v109, v109, v101
    v_mul_f32 v110, v110, v102
    v_mul_f32 v111, v111, v103
    v_cvt_pk_bf16_f32 v50, v108, v109
    v_cvt_pk_bf16_f32 v51, v110, v111
    ds_write_b64 v107, v[50:51] offset:30288
    s_cbranch_vccz gather_scatter__molecular_angular_gemnet__graph_kernel_noovfT1b
    s_mov_b64 exec, vcc
    v_lshlrev_b32 v106, 1, v90
    ds_add_f32 v106, v108 offset:3232
    ds_add_f32 v106, v109 offset:3236
    ds_add_f32 v106, v110 offset:3240
    ds_add_f32 v106, v111 offset:3244
    s_waitcnt lgkmcnt(0)
gather_scatter__molecular_angular_gemnet__graph_kernel_noovfT1b:
    s_mov_b64 exec, -1
    v_mov_b32 v112, 2560
    v_add_u32 v114, 0x7650, v5
    s_waitcnt lgkmcnt(0)
    s_waitcnt vmcnt(0)
    s_barrier
    ds_read_b32 v113, v112
    s_cmp_ge_u32 s32, 10
    s_cbranch_scc1 gather_scatter__molecular_angular_gemnet__graph_kernel_noredb
    ds_read2st64_b64 v[24:27], v114 offset0:0 offset1:10
    ds_read2st64_b64 v[28:31], v114 offset0:20 offset1:30
    ds_read2st64_b64 v[32:35], v114 offset0:40 offset1:50
    ds_read2st64_b64 v[36:39], v114 offset0:60 offset1:70
    ds_read2st64_b64 v[40:43], v114 offset0:80 offset1:90
    ds_read2st64_b64 v[44:47], v114 offset0:100 offset1:110
    ds_read2st64_b64 v[48:51], v114 offset0:120 offset1:130
    ds_read2st64_b64 v[52:55], v114 offset0:140 offset1:150
    ds_read2st64_b64 v[56:59], v114 offset0:160 offset1:170
    ds_read2st64_b64 v[60:63], v114 offset0:180 offset1:190
    ds_read2st64_b64 v[64:67], v114 offset0:200 offset1:210
    ds_read2st64_b64 v[68:71], v114 offset0:220 offset1:230
    ds_read2st64_b64 v[72:75], v114 offset0:240 offset1:250
    s_waitcnt lgkmcnt(12)
    v_mfma_f32_4x4x4_16b_bf16 v[92:95], v[2:3], v[24:25], v[10:13]
    v_mfma_f32_4x4x4_16b_bf16 v[96:99], v[2:3], v[26:27], 0
    s_waitcnt lgkmcnt(11)
    v_mfma_f32_4x4x4_16b_bf16 v[100:103], v[2:3], v[28:29], 0
    v_mfma_f32_4x4x4_16b_bf16 v[104:107], v[2:3], v[30:31], 0
    s_waitcnt lgkmcnt(10)
    v_mfma_f32_4x4x4_16b_bf16 v[92:95], v[2:3], v[32:33], v[92:95]
    v_mfma_f32_4x4x4_16b_bf16 v[96:99], v[2:3], v[34:35], v[96:99]
    s_waitcnt lgkmcnt(9)
    v_mfma_f32_4x4x4_16b_bf16 v[100:103], v[2:3], v[36:37], v[100:103]
    v_mfma_f32_4x4x4_16b_bf16 v[104:107], v[2:3], v[38:39], v[104:107]
    s_waitcnt lgkmcnt(8)
    v_mfma_f32_4x4x4_16b_bf16 v[92:95], v[2:3], v[40:41], v[92:95]
    v_mfma_f32_4x4x4_16b_bf16 v[96:99], v[2:3], v[42:43], v[96:99]
    s_waitcnt lgkmcnt(7)
    v_mfma_f32_4x4x4_16b_bf16 v[100:103], v[2:3], v[44:45], v[100:103]
    v_mfma_f32_4x4x4_16b_bf16 v[104:107], v[2:3], v[46:47], v[104:107]
    s_waitcnt lgkmcnt(6)
    v_mfma_f32_4x4x4_16b_bf16 v[92:95], v[2:3], v[48:49], v[92:95]
    v_mfma_f32_4x4x4_16b_bf16 v[96:99], v[2:3], v[50:51], v[96:99]
    s_waitcnt lgkmcnt(5)
    v_mfma_f32_4x4x4_16b_bf16 v[100:103], v[2:3], v[52:53], v[100:103]
    v_mfma_f32_4x4x4_16b_bf16 v[104:107], v[2:3], v[54:55], v[104:107]
    s_waitcnt lgkmcnt(4)
    v_mfma_f32_4x4x4_16b_bf16 v[92:95], v[2:3], v[56:57], v[92:95]
    v_mfma_f32_4x4x4_16b_bf16 v[96:99], v[2:3], v[58:59], v[96:99]
    s_waitcnt lgkmcnt(3)
    v_mfma_f32_4x4x4_16b_bf16 v[100:103], v[2:3], v[60:61], v[100:103]
    v_mfma_f32_4x4x4_16b_bf16 v[104:107], v[2:3], v[62:63], v[104:107]
    s_waitcnt lgkmcnt(2)
    v_mfma_f32_4x4x4_16b_bf16 v[92:95], v[2:3], v[64:65], v[92:95]
    v_mfma_f32_4x4x4_16b_bf16 v[96:99], v[2:3], v[66:67], v[96:99]
    s_waitcnt lgkmcnt(1)
    v_mfma_f32_4x4x4_16b_bf16 v[100:103], v[2:3], v[68:69], v[100:103]
    v_mfma_f32_4x4x4_16b_bf16 v[104:107], v[2:3], v[70:71], v[104:107]
    s_waitcnt lgkmcnt(0)
    v_mfma_f32_4x4x4_16b_bf16 v[92:95], v[2:3], v[72:73], v[92:95]
    s_nop 4
    v_pk_add_f32 v[96:97], v[96:97], v[100:101]
    v_pk_add_f32 v[98:99], v[98:99], v[102:103]
    v_pk_add_f32 v[92:93], v[92:93], v[104:105]
    v_pk_add_f32 v[94:95], v[94:95], v[106:107]
    v_pk_add_f32 v[10:11], v[92:93], v[96:97]
    v_pk_add_f32 v[12:13], v[94:95], v[98:99]
gather_scatter__molecular_angular_gemnet__graph_kernel_noredb:
    s_waitcnt lgkmcnt(0)
    v_readfirstlane_b32 s39, v113
    s_add_u32 s34, s34, 128
    s_cmp_lg_u32 s39, s34
    s_cbranch_scc0 gather_scatter__molecular_angular_gemnet__graph_kernel_round
gather_scatter__molecular_angular_gemnet__graph_kernel_final:
    s_cmp_ge_u32 s32, 10
    s_cbranch_scc1 gather_scatter__molecular_angular_gemnet__graph_kernel_fin2
    v_lshlrev_b32 v108, 4, v0
    ds_read_b128 v[92:95], v108 offset:3232
    s_waitcnt vmcnt(0) lgkmcnt(0)
    v_add_f32 v10, v10, v92
    v_add_f32 v11, v11, v93
    v_add_f32 v12, v12, v94
    v_add_f32 v13, v13, v95
    v_cvt_pk_bf16_f32 v92, v10, v11
    v_cvt_pk_bf16_f32 v93, v12, v13
    v_dot2_f32_bf16 v94, v92, s16, 0
    v_dot2_f32_bf16 v95, v92, s18, 0
    v_dot2_f32_bf16 v96, v92, s20, 0
    v_dot2_f32_bf16 v97, v92, s22, 0
    v_dot2c_f32_bf16 v94, s17, v93
    v_dot2c_f32_bf16 v95, s19, v93
    v_dot2c_f32_bf16 v96, s21, v93
    v_dot2c_f32_bf16 v97, s23, v93
    s_nop 2
    v_cvt_pk_bf16_f32 v92, v94, v95
    v_cvt_pk_bf16_f32 v93, v96, v97
    v_lshlrev_b32 v94, 16, v92
    v_and_b32 v95, 0xffff0000, v92
    v_lshlrev_b32 v96, 16, v93
    v_and_b32 v97, 0xffff0000, v93
    v_lshlrev_b32 v98, 16, v8
    v_and_b32 v99, 0xffff0000, v8
    v_lshlrev_b32 v100, 16, v9
    v_and_b32 v101, 0xffff0000, v9
    v_mul_f32 v94, v94, v98
    v_mul_f32 v95, v95, v99
    v_mul_f32 v96, v96, v100
    v_mul_f32 v97, v97, v101
    v_cvt_pk_bf16_f32 v92, v94, v95
    v_cvt_pk_bf16_f32 v93, v96, v97
    v_lshlrev_b32 v94, 16, v92
    v_and_b32 v95, 0xffff0000, v92
    v_lshlrev_b32 v96, 16, v93
    v_and_b32 v97, 0xffff0000, v93
    v_lshlrev_b32 v98, 16, v6
    v_and_b32 v99, 0xffff0000, v6
    v_lshlrev_b32 v100, 16, v7
    v_and_b32 v101, 0xffff0000, v7
    v_add_f32 v94, v94, v98
    v_add_f32 v95, v95, v99
    v_add_f32 v96, v96, v100
    v_add_f32 v97, v97, v101
    v_cvt_pk_bf16_f32 v92, v94, v95
    v_cvt_pk_bf16_f32 v93, v96, v97
    buffer_store_dwordx2 v[92:93], v5, s[12:15], 0 offen
gather_scatter__molecular_angular_gemnet__graph_kernel_fin2:
gather_scatter__molecular_angular_gemnet__graph_kernel_end:
    s_endpgm
gather_scatter__molecular_angular_gemnet__graph_kernel_slow:
    s_mov_b64 exec, -1
    s_waitcnt vmcnt(0) lgkmcnt(0)
    v_lshrrev_b32 v108, 6, v0
    v_lshrrev_b32 v113, 3, v1
    v_lshl_add_u32 v114, v108, 4, v113
    v_lshlrev_b32 v113, 16, v114
    v_and_b32 v109, 7, v1
    v_lshl_add_u32 v113, v109, 4, v113
    s_lshl_b32 s90, s3, 8
    v_add_u32 v113, s90, v113
    v_add_u32 v115, 0x80000, v113
    buffer_load_dwordx4 v[72:75], v113, s[4:7], 0 offen
    buffer_load_dwordx4 v[76:79], v113, s[4:7], 0 offen offset:128
    buffer_load_dwordx4 v[80:83], v115, s[4:7], 0 offen
    buffer_load_dwordx4 v[84:87], v115, s[4:7], 0 offen offset:128
    s_barrier
    v_mov_b32 v116, 0
    v_mov_b32 v117, 0
    v_mov_b32 v118, 0
    v_mov_b32 v119, 0
    v_lshlrev_b32 v112, 4, v0
    v_add_u32 v110, 0x7650, v112
    v_add_u32 v111, 0x17650, v112
    ds_write_b128 v110, v[116:119] offset:0
    ds_write_b128 v110, v[116:119] offset:16384
    ds_write_b128 v110, v[116:119] offset:32768
    ds_write_b128 v110, v[116:119] offset:49152
    ds_write_b128 v111, v[116:119] offset:0
    ds_write_b128 v111, v[116:119] offset:16384
    ds_write_b128 v111, v[116:119] offset:32768
    ds_write_b128 v111, v[116:119] offset:49152
    s_mov_b32 exec_lo, 0x11111111
    s_mov_b32 exec_hi, 0x11111111
    v_mov_b32 v122, s24
    v_mov_b32 v123, s25
    s_mov_b32 exec_lo, 0x22222222
    s_mov_b32 exec_hi, 0x22222222
    v_mov_b32 v122, s26
    v_mov_b32 v123, s27
    s_mov_b32 exec_lo, 0x44444444
    s_mov_b32 exec_hi, 0x44444444
    v_mov_b32 v122, s28
    v_mov_b32 v123, s29
    s_mov_b32 exec_lo, 0x88888888
    s_mov_b32 exec_hi, 0x88888888
    v_mov_b32 v122, s30
    v_mov_b32 v123, s31
    s_mov_b64 exec, -1
    s_waitcnt vmcnt(0) lgkmcnt(0)
    s_barrier
    s_mov_b64 exec, -1
    v_lshrrev_b32 v126, 16, v79
    v_and_b32 v124, 7, v1
    s_nop 0
    v_sub_u32_dpp v124, v126, v124 quad_perm:[1,1,3,3] row_mask:0xf bank_mask:0xf
    v_cmp_lt_i32_e64 s[40:41], 0, v124
    s_mov_b64 exec, s[40:41]
    v_lshrrev_b32 v24, 10, v72
    v_and_b32 v72, 0x3ff, v72
    buffer_load_dwordx2 v[24:25], v24, s[8:11], 0 offen
    v_lshlrev_b32 v72, 3, v72
    s_mov_b64 exec, s[40:41]
    v_lshrrev_b32 v116, 1, v72
    ds_add_rtn_u32 v54, v116, v4 offset:0
    s_mov_b64 exec, s[40:41]
    v_lshlrev_b32 v98, 1, v72
    ds_read_b128 v[92:95], v98 offset:13232
    ds_read_b64 v[96:97], v72 offset:23232
    s_mov_b64 exec, s[40:41]
    v_lshlrev_b32 v112, 16, v77
    v_mul_f32 v112, 0.15915494, v112
    v_fract_f32 v112, v112
    v_cos_f32 v112, v112
    s_nop 0
    v_add_f32 v114, v112, v112
    v_fma_f32 v113, v114, v112, -1.0
    v_fma_f32 v114, v114, v113, -v112
    v_cvt_pk_bf16_f32 v115, v112, v113
    v_cvt_pk_bf16_f32 v114, 0, v114
    s_waitcnt lgkmcnt(2)
    s_waitcnt lgkmcnt(0)
    v_dot2_f32_bf16 v92, v92, v115, 0
    v_dot2_f32_bf16 v93, v93, v115, 0
    v_dot2_f32_bf16 v94, v94, v115, 0
    v_dot2_f32_bf16 v95, v95, v115, 0
    v_lshlrev_b32 v112, 16, v96
    v_and_b32 v96, 0xffff0000, v96
    v_lshlrev_b32 v113, 16, v97
    v_and_b32 v97, 0xffff0000, v97
    v_fmac_f32 v92, v112, v114
    v_fmac_f32 v93, v96, v114
    v_fmac_f32 v94, v113, v114
    v_fmac_f32 v95, v97, v114
    s_waitcnt vmcnt(0)
    s_mov_b64 exec, -1
    v_mfma_f32_4x4x4_16b_bf16 v[108:111], v[122:123], v[24:25], 0
    s_mov_b64 exec, s[40:41]
    v_min_u32 v99, 25, v54
    v_cmp_le_u32 vcc, 25, v54
    v_mad_u32_u24 v99, v99, s89, v72
    s_nop 0
    v_mul_f32 v108, v108, v92
    v_mul_f32 v109, v109, v93
    v_mul_f32 v110, v110, v94
    v_mul_f32 v111, v111, v95
    v_cvt_pk_bf16_f32 v24, v108, v109
    v_cvt_pk_bf16_f32 v25, v110, v111
    ds_write_b64 v99, v[24:25] offset:30288
    s_cbranch_vccz gather_scatter__molecular_angular_gemnet__graph_kernel_noovfZ0z
    s_mov_b64 exec, vcc
    v_lshlrev_b32 v98, 1, v72
    ds_add_f32 v98, v108 offset:3232
    ds_add_f32 v98, v109 offset:3236
    ds_add_f32 v98, v110 offset:3240
    ds_add_f32 v98, v111 offset:3244
    s_waitcnt lgkmcnt(0)
gather_scatter__molecular_angular_gemnet__graph_kernel_noovfZ0z:
    s_mov_b64 exec, -1
    v_cmp_lt_i32_e64 s[42:43], 8, v124
    s_mov_b64 exec, s[42:43]
    v_lshrrev_b32 v26, 10, v73
    v_and_b32 v73, 0x3ff, v73
    buffer_load_dwordx2 v[26:27], v26, s[8:11], 0 offen
    v_lshlrev_b32 v73, 3, v73
    s_mov_b64 exec, s[42:43]
    v_lshrrev_b32 v117, 1, v73
    ds_add_rtn_u32 v55, v117, v4 offset:0
    s_mov_b64 exec, s[42:43]
    v_lshlrev_b32 v106, 1, v73
    ds_read_b128 v[100:103], v106 offset:13232
    ds_read_b64 v[104:105], v73 offset:23232
    s_mov_b64 exec, s[42:43]
    v_and_b32 v112, 0xffff0000, v77
    v_mul_f32 v112, 0.15915494, v112
    v_fract_f32 v112, v112
    v_cos_f32 v112, v112
    s_nop 0
    v_add_f32 v114, v112, v112
    v_fma_f32 v113, v114, v112, -1.0
    v_fma_f32 v114, v114, v113, -v112
    v_cvt_pk_bf16_f32 v115, v112, v113
    v_cvt_pk_bf16_f32 v114, 0, v114
    s_waitcnt lgkmcnt(2)
    s_waitcnt lgkmcnt(0)
    v_dot2_f32_bf16 v100, v100, v115, 0
    v_dot2_f32_bf16 v101, v101, v115, 0
    v_dot2_f32_bf16 v102, v102, v115, 0
    v_dot2_f32_bf16 v103, v103, v115, 0
    v_lshlrev_b32 v112, 16, v104
    v_and_b32 v104, 0xffff0000, v104
    v_lshlrev_b32 v113, 16, v105
    v_and_b32 v105, 0xffff0000, v105
    v_fmac_f32 v100, v112, v114
    v_fmac_f32 v101, v104, v114
    v_fmac_f32 v102, v113, v114
    v_fmac_f32 v103, v105, v114
    s_waitcnt vmcnt(0)
    s_mov_b64 exec, -1
    v_mfma_f32_4x4x4_16b_bf16 v[108:111], v[122:123], v[26:27], 0
    s_mov_b64 exec, s[42:43]
    v_min_u32 v107, 25, v55
    v_cmp_le_u32 vcc, 25, v55
    v_mad_u32_u24 v107, v107, s89, v73
    s_nop 0
    v_mul_f32 v108, v108, v100
    v_mul_f32 v109, v109, v101
    v_mul_f32 v110, v110, v102
    v_mul_f32 v111, v111, v103
    v_cvt_pk_bf16_f32 v26, v108, v109
    v_cvt_pk_bf16_f32 v27, v110, v111
    ds_write_b64 v107, v[26:27] offset:30288
    s_cbranch_vccz gather_scatter__molecular_angular_gemnet__graph_kernel_noovfZ1z
    s_mov_b64 exec, vcc
    v_lshlrev_b32 v106, 1, v73
    ds_add_f32 v106, v108 offset:3232
    ds_add_f32 v106, v109 offset:3236
    ds_add_f32 v106, v110 offset:3240
    ds_add_f32 v106, v111 offset:3244
    s_waitcnt lgkmcnt(0)
gather_scatter__molecular_angular_gemnet__graph_kernel_noovfZ1z:
    s_mov_b64 exec, -1
    v_cmp_lt_i32_e64 s[44:45], 16, v124
    s_mov_b64 exec, s[44:45]
    v_lshrrev_b32 v28, 10, v74
    v_and_b32 v74, 0x3ff, v74
    buffer_load_dwordx2 v[28:29], v28, s[8:11], 0 offen
    v_lshlrev_b32 v74, 3, v74
    s_mov_b64 exec, s[44:45]
    v_lshrrev_b32 v116, 1, v74
    ds_add_rtn_u32 v56, v116, v4 offset:0
    s_mov_b64 exec, s[44:45]
    v_lshlrev_b32 v98, 1, v74
    ds_read_b128 v[92:95], v98 offset:13232
    ds_read_b64 v[96:97], v74 offset:23232
    s_mov_b64 exec, s[44:45]
    v_lshlrev_b32 v112, 16, v78
    v_mul_f32 v112, 0.15915494, v112
    v_fract_f32 v112, v112
    v_cos_f32 v112, v112
    s_nop 0
    v_add_f32 v114, v112, v112
    v_fma_f32 v113, v114, v112, -1.0
    v_fma_f32 v114, v114, v113, -v112
    v_cvt_pk_bf16_f32 v115, v112, v113
    v_cvt_pk_bf16_f32 v114, 0, v114
    s_waitcnt lgkmcnt(2)
    s_waitcnt lgkmcnt(0)
    v_dot2_f32_bf16 v92, v92, v115, 0
    v_dot2_f32_bf16 v93, v93, v115, 0
    v_dot2_f32_bf16 v94, v94, v115, 0
    v_dot2_f32_bf16 v95, v95, v115, 0
    v_lshlrev_b32 v112, 16, v96
    v_and_b32 v96, 0xffff0000, v96
    v_lshlrev_b32 v113, 16, v97
    v_and_b32 v97, 0xffff0000, v97
    v_fmac_f32 v92, v112, v114
    v_fmac_f32 v93, v96, v114
    v_fmac_f32 v94, v113, v114
    v_fmac_f32 v95, v97, v114
    s_waitcnt vmcnt(0)
    s_mov_b64 exec, -1
    v_mfma_f32_4x4x4_16b_bf16 v[108:111], v[122:123], v[28:29], 0
    s_mov_b64 exec, s[44:45]
    v_min_u32 v99, 25, v56
    v_cmp_le_u32 vcc, 25, v56
    v_mad_u32_u24 v99, v99, s89, v74
    s_nop 0
    v_mul_f32 v108, v108, v92
    v_mul_f32 v109, v109, v93
    v_mul_f32 v110, v110, v94
    v_mul_f32 v111, v111, v95
    v_cvt_pk_bf16_f32 v28, v108, v109
    v_cvt_pk_bf16_f32 v29, v110, v111
    ds_write_b64 v99, v[28:29] offset:30288
    s_cbranch_vccz gather_scatter__molecular_angular_gemnet__graph_kernel_noovfZ2z
    s_mov_b64 exec, vcc
    v_lshlrev_b32 v98, 1, v74
    ds_add_f32 v98, v108 offset:3232
    ds_add_f32 v98, v109 offset:3236
    ds_add_f32 v98, v110 offset:3240
    ds_add_f32 v98, v111 offset:3244
    s_waitcnt lgkmcnt(0)
gather_scatter__molecular_angular_gemnet__graph_kernel_noovfZ2z:
    s_mov_b64 exec, -1
    v_cmp_lt_i32_e64 s[46:47], 24, v124
    s_mov_b64 exec, s[46:47]
    v_lshrrev_b32 v30, 10, v75
    v_and_b32 v75, 0x3ff, v75
    buffer_load_dwordx2 v[30:31], v30, s[8:11], 0 offen
    v_lshlrev_b32 v75, 3, v75
    s_mov_b64 exec, s[46:47]
    v_lshrrev_b32 v117, 1, v75
    ds_add_rtn_u32 v57, v117, v4 offset:0
    s_mov_b64 exec, s[46:47]
    v_lshlrev_b32 v106, 1, v75
    ds_read_b128 v[100:103], v106 offset:13232
    ds_read_b64 v[104:105], v75 offset:23232
    s_mov_b64 exec, s[46:47]
    v_and_b32 v112, 0xffff0000, v78
    v_mul_f32 v112, 0.15915494, v112
    v_fract_f32 v112, v112
    v_cos_f32 v112, v112
    s_nop 0
    v_add_f32 v114, v112, v112
    v_fma_f32 v113, v114, v112, -1.0
    v_fma_f32 v114, v114, v113, -v112
    v_cvt_pk_bf16_f32 v115, v112, v113
    v_cvt_pk_bf16_f32 v114, 0, v114
    s_waitcnt lgkmcnt(2)
    s_waitcnt lgkmcnt(0)
    v_dot2_f32_bf16 v100, v100, v115, 0
    v_dot2_f32_bf16 v101, v101, v115, 0
    v_dot2_f32_bf16 v102, v102, v115, 0
    v_dot2_f32_bf16 v103, v103, v115, 0
    v_lshlrev_b32 v112, 16, v104
    v_and_b32 v104, 0xffff0000, v104
    v_lshlrev_b32 v113, 16, v105
    v_and_b32 v105, 0xffff0000, v105
    v_fmac_f32 v100, v112, v114
    v_fmac_f32 v101, v104, v114
    v_fmac_f32 v102, v113, v114
    v_fmac_f32 v103, v105, v114
    s_waitcnt vmcnt(0)
    s_mov_b64 exec, -1
    v_mfma_f32_4x4x4_16b_bf16 v[108:111], v[122:123], v[30:31], 0
    s_mov_b64 exec, s[46:47]
    v_min_u32 v107, 25, v57
    v_cmp_le_u32 vcc, 25, v57
    v_mad_u32_u24 v107, v107, s89, v75
    s_nop 0
    v_mul_f32 v108, v108, v100
    v_mul_f32 v109, v109, v101
    v_mul_f32 v110, v110, v102
    v_mul_f32 v111, v111, v103
    v_cvt_pk_bf16_f32 v30, v108, v109
    v_cvt_pk_bf16_f32 v31, v110, v111
    ds_write_b64 v107, v[30:31] offset:30288
    s_cbranch_vccz gather_scatter__molecular_angular_gemnet__graph_kernel_noovfZ3z
    s_mov_b64 exec, vcc
    v_lshlrev_b32 v106, 1, v75
    ds_add_f32 v106, v108 offset:3232
    ds_add_f32 v106, v109 offset:3236
    ds_add_f32 v106, v110 offset:3240
    ds_add_f32 v106, v111 offset:3244
    s_waitcnt lgkmcnt(0)
gather_scatter__molecular_angular_gemnet__graph_kernel_noovfZ3z:
    s_mov_b64 exec, -1
    v_cmp_lt_i32_e64 s[48:49], 32, v124
    s_mov_b64 exec, s[48:49]
    v_lshrrev_b32 v32, 10, v76
    v_and_b32 v76, 0x3ff, v76
    buffer_load_dwordx2 v[32:33], v32, s[8:11], 0 offen
    v_lshlrev_b32 v76, 3, v76
    s_mov_b64 exec, s[48:49]
    v_lshrrev_b32 v116, 1, v76
    ds_add_rtn_u32 v54, v116, v4 offset:0
    s_mov_b64 exec, s[48:49]
    v_lshlrev_b32 v98, 1, v76
    ds_read_b128 v[92:95], v98 offset:13232
    ds_read_b64 v[96:97], v76 offset:23232
    s_mov_b64 exec, s[48:49]
    v_lshlrev_b32 v112, 16, v79
    v_mul_f32 v112, 0.15915494, v112
    v_fract_f32 v112, v112
    v_cos_f32 v112, v112
    s_nop 0
    v_add_f32 v114, v112, v112
    v_fma_f32 v113, v114, v112, -1.0
    v_fma_f32 v114, v114, v113, -v112
    v_cvt_pk_bf16_f32 v115, v112, v113
    v_cvt_pk_bf16_f32 v114, 0, v114
    s_waitcnt lgkmcnt(2)
    s_waitcnt lgkmcnt(0)
    v_dot2_f32_bf16 v92, v92, v115, 0
    v_dot2_f32_bf16 v93, v93, v115, 0
    v_dot2_f32_bf16 v94, v94, v115, 0
    v_dot2_f32_bf16 v95, v95, v115, 0
    v_lshlrev_b32 v112, 16, v96
    v_and_b32 v96, 0xffff0000, v96
    v_lshlrev_b32 v113, 16, v97
    v_and_b32 v97, 0xffff0000, v97
    v_fmac_f32 v92, v112, v114
    v_fmac_f32 v93, v96, v114
    v_fmac_f32 v94, v113, v114
    v_fmac_f32 v95, v97, v114
    s_waitcnt vmcnt(0)
    s_mov_b64 exec, -1
    v_mfma_f32_4x4x4_16b_bf16 v[108:111], v[122:123], v[32:33], 0
    s_mov_b64 exec, s[48:49]
    v_min_u32 v99, 25, v54
    v_cmp_le_u32 vcc, 25, v54
    v_mad_u32_u24 v99, v99, s89, v76
    s_nop 0
    v_mul_f32 v108, v108, v92
    v_mul_f32 v109, v109, v93
    v_mul_f32 v110, v110, v94
    v_mul_f32 v111, v111, v95
    v_cvt_pk_bf16_f32 v32, v108, v109
    v_cvt_pk_bf16_f32 v33, v110, v111
    ds_write_b64 v99, v[32:33] offset:30288
    s_cbranch_vccz gather_scatter__molecular_angular_gemnet__graph_kernel_noovfZ4z
    s_mov_b64 exec, vcc
    v_lshlrev_b32 v98, 1, v76
    ds_add_f32 v98, v108 offset:3232
    ds_add_f32 v98, v109 offset:3236
    ds_add_f32 v98, v110 offset:3240
    ds_add_f32 v98, v111 offset:3244
    s_waitcnt lgkmcnt(0)
gather_scatter__molecular_angular_gemnet__graph_kernel_noovfZ4z:
    s_mov_b64 exec, -1
    v_lshrrev_b32 v127, 16, v87
    v_and_b32 v125, 7, v1
    s_nop 0
    v_sub_u32_dpp v125, v127, v125 quad_perm:[1,1,3,3] row_mask:0xf bank_mask:0xf
    v_cmp_lt_i32_e64 s[50:51], 0, v125
    s_mov_b64 exec, s[50:51]
    v_lshrrev_b32 v34, 10, v80
    v_and_b32 v80, 0x3ff, v80
    buffer_load_dwordx2 v[34:35], v34, s[8:11], 0 offen
    v_lshlrev_b32 v80, 3, v80
    s_mov_b64 exec, s[50:51]
    v_lshrrev_b32 v117, 1, v80
    ds_add_rtn_u32 v55, v117, v4 offset:0
    s_mov_b64 exec, s[50:51]
    v_lshlrev_b32 v106, 1, v80
    ds_read_b128 v[100:103], v106 offset:13232
    ds_read_b64 v[104:105], v80 offset:23232
    s_mov_b64 exec, s[50:51]
    v_lshlrev_b32 v112, 16, v85
    v_mul_f32 v112, 0.15915494, v112
    v_fract_f32 v112, v112
    v_cos_f32 v112, v112
    s_nop 0
    v_add_f32 v114, v112, v112
    v_fma_f32 v113, v114, v112, -1.0
    v_fma_f32 v114, v114, v113, -v112
    v_cvt_pk_bf16_f32 v115, v112, v113
    v_cvt_pk_bf16_f32 v114, 0, v114
    s_waitcnt lgkmcnt(2)
    s_waitcnt lgkmcnt(0)
    v_dot2_f32_bf16 v100, v100, v115, 0
    v_dot2_f32_bf16 v101, v101, v115, 0
    v_dot2_f32_bf16 v102, v102, v115, 0
    v_dot2_f32_bf16 v103, v103, v115, 0
    v_lshlrev_b32 v112, 16, v104
    v_and_b32 v104, 0xffff0000, v104
    v_lshlrev_b32 v113, 16, v105
    v_and_b32 v105, 0xffff0000, v105
    v_fmac_f32 v100, v112, v114
    v_fmac_f32 v101, v104, v114
    v_fmac_f32 v102, v113, v114
    v_fmac_f32 v103, v105, v114
    s_waitcnt vmcnt(0)
    s_mov_b64 exec, -1
    v_mfma_f32_4x4x4_16b_bf16 v[108:111], v[122:123], v[34:35], 0
    s_mov_b64 exec, s[50:51]
    v_min_u32 v107, 25, v55
    v_cmp_le_u32 vcc, 25, v55
    v_mad_u32_u24 v107, v107, s89, v80
    s_nop 0
    v_mul_f32 v108, v108, v100
    v_mul_f32 v109, v109, v101
    v_mul_f32 v110, v110, v102
    v_mul_f32 v111, v111, v103
    v_cvt_pk_bf16_f32 v34, v108, v109
    v_cvt_pk_bf16_f32 v35, v110, v111
    ds_write_b64 v107, v[34:35] offset:30288
    s_cbranch_vccz gather_scatter__molecular_angular_gemnet__graph_kernel_noovfZ5z
    s_mov_b64 exec, vcc
    v_lshlrev_b32 v106, 1, v80
    ds_add_f32 v106, v108 offset:3232
    ds_add_f32 v106, v109 offset:3236
    ds_add_f32 v106, v110 offset:3240
    ds_add_f32 v106, v111 offset:3244
    s_waitcnt lgkmcnt(0)
gather_scatter__molecular_angular_gemnet__graph_kernel_noovfZ5z:
    s_mov_b64 exec, -1
    v_cmp_lt_i32_e64 s[52:53], 8, v125
    s_mov_b64 exec, s[52:53]
    v_lshrrev_b32 v36, 10, v81
    v_and_b32 v81, 0x3ff, v81
    buffer_load_dwordx2 v[36:37], v36, s[8:11], 0 offen
    v_lshlrev_b32 v81, 3, v81
    s_mov_b64 exec, s[52:53]
    v_lshrrev_b32 v116, 1, v81
    ds_add_rtn_u32 v56, v116, v4 offset:0
    s_mov_b64 exec, s[52:53]
    v_lshlrev_b32 v98, 1, v81
    ds_read_b128 v[92:95], v98 offset:13232
    ds_read_b64 v[96:97], v81 offset:23232
    s_mov_b64 exec, s[52:53]
    v_and_b32 v112, 0xffff0000, v85
    v_mul_f32 v112, 0.15915494, v112
    v_fract_f32 v112, v112
    v_cos_f32 v112, v112
    s_nop 0
    v_add_f32 v114, v112, v112
    v_fma_f32 v113, v114, v112, -1.0
    v_fma_f32 v114, v114, v113, -v112
    v_cvt_pk_bf16_f32 v115, v112, v113
    v_cvt_pk_bf16_f32 v114, 0, v114
    s_waitcnt lgkmcnt(2)
    s_waitcnt lgkmcnt(0)
    v_dot2_f32_bf16 v92, v92, v115, 0
    v_dot2_f32_bf16 v93, v93, v115, 0
    v_dot2_f32_bf16 v94, v94, v115, 0
    v_dot2_f32_bf16 v95, v95, v115, 0
    v_lshlrev_b32 v112, 16, v96
    v_and_b32 v96, 0xffff0000, v96
    v_lshlrev_b32 v113, 16, v97
    v_and_b32 v97, 0xffff0000, v97
    v_fmac_f32 v92, v112, v114
    v_fmac_f32 v93, v96, v114
    v_fmac_f32 v94, v113, v114
    v_fmac_f32 v95, v97, v114
    s_waitcnt vmcnt(0)
    s_mov_b64 exec, -1
    v_mfma_f32_4x4x4_16b_bf16 v[108:111], v[122:123], v[36:37], 0
    s_mov_b64 exec, s[52:53]
    v_min_u32 v99, 25, v56
    v_cmp_le_u32 vcc, 25, v56
    v_mad_u32_u24 v99, v99, s89, v81
    s_nop 0
    v_mul_f32 v108, v108, v92
    v_mul_f32 v109, v109, v93
    v_mul_f32 v110, v110, v94
    v_mul_f32 v111, v111, v95
    v_cvt_pk_bf16_f32 v36, v108, v109
    v_cvt_pk_bf16_f32 v37, v110, v111
    ds_write_b64 v99, v[36:37] offset:30288
    s_cbranch_vccz gather_scatter__molecular_angular_gemnet__graph_kernel_noovfZ6z
    s_mov_b64 exec, vcc
    v_lshlrev_b32 v98, 1, v81
    ds_add_f32 v98, v108 offset:3232
    ds_add_f32 v98, v109 offset:3236
    ds_add_f32 v98, v110 offset:3240
    ds_add_f32 v98, v111 offset:3244
    s_waitcnt lgkmcnt(0)
gather_scatter__molecular_angular_gemnet__graph_kernel_noovfZ6z:
    s_mov_b64 exec, -1
    v_cmp_lt_i32_e64 s[54:55], 16, v125
    s_mov_b64 exec, s[54:55]
    v_lshrrev_b32 v38, 10, v82
    v_and_b32 v82, 0x3ff, v82
    buffer_load_dwordx2 v[38:39], v38, s[8:11], 0 offen
    v_lshlrev_b32 v82, 3, v82
    s_mov_b64 exec, s[54:55]
    v_lshrrev_b32 v117, 1, v82
    ds_add_rtn_u32 v57, v117, v4 offset:0
    s_mov_b64 exec, s[54:55]
    v_lshlrev_b32 v106, 1, v82
    ds_read_b128 v[100:103], v106 offset:13232
    ds_read_b64 v[104:105], v82 offset:23232
    s_mov_b64 exec, s[54:55]
    v_lshlrev_b32 v112, 16, v86
    v_mul_f32 v112, 0.15915494, v112
    v_fract_f32 v112, v112
    v_cos_f32 v112, v112
    s_nop 0
    v_add_f32 v114, v112, v112
    v_fma_f32 v113, v114, v112, -1.0
    v_fma_f32 v114, v114, v113, -v112
    v_cvt_pk_bf16_f32 v115, v112, v113
    v_cvt_pk_bf16_f32 v114, 0, v114
    s_waitcnt lgkmcnt(2)
    s_waitcnt lgkmcnt(0)
    v_dot2_f32_bf16 v100, v100, v115, 0
    v_dot2_f32_bf16 v101, v101, v115, 0
    v_dot2_f32_bf16 v102, v102, v115, 0
    v_dot2_f32_bf16 v103, v103, v115, 0
    v_lshlrev_b32 v112, 16, v104
    v_and_b32 v104, 0xffff0000, v104
    v_lshlrev_b32 v113, 16, v105
    v_and_b32 v105, 0xffff0000, v105
    v_fmac_f32 v100, v112, v114
    v_fmac_f32 v101, v104, v114
    v_fmac_f32 v102, v113, v114
    v_fmac_f32 v103, v105, v114
    s_waitcnt vmcnt(0)
    s_mov_b64 exec, -1
    v_mfma_f32_4x4x4_16b_bf16 v[108:111], v[122:123], v[38:39], 0
    s_mov_b64 exec, s[54:55]
    v_min_u32 v107, 25, v57
    v_cmp_le_u32 vcc, 25, v57
    v_mad_u32_u24 v107, v107, s89, v82
    s_nop 0
    v_mul_f32 v108, v108, v100
    v_mul_f32 v109, v109, v101
    v_mul_f32 v110, v110, v102
    v_mul_f32 v111, v111, v103
    v_cvt_pk_bf16_f32 v38, v108, v109
    v_cvt_pk_bf16_f32 v39, v110, v111
    ds_write_b64 v107, v[38:39] offset:30288
    s_cbranch_vccz gather_scatter__molecular_angular_gemnet__graph_kernel_noovfZ7z
    s_mov_b64 exec, vcc
    v_lshlrev_b32 v106, 1, v82
    ds_add_f32 v106, v108 offset:3232
    ds_add_f32 v106, v109 offset:3236
    ds_add_f32 v106, v110 offset:3240
    ds_add_f32 v106, v111 offset:3244
    s_waitcnt lgkmcnt(0)
gather_scatter__molecular_angular_gemnet__graph_kernel_noovfZ7z:
    s_mov_b64 exec, -1
    v_cmp_lt_i32_e64 s[56:57], 24, v125
    s_mov_b64 exec, s[56:57]
    v_lshrrev_b32 v40, 10, v83
    v_and_b32 v83, 0x3ff, v83
    buffer_load_dwordx2 v[40:41], v40, s[8:11], 0 offen
    v_lshlrev_b32 v83, 3, v83
    s_mov_b64 exec, s[56:57]
    v_lshrrev_b32 v116, 1, v83
    ds_add_rtn_u32 v54, v116, v4 offset:0
    s_mov_b64 exec, s[56:57]
    v_lshlrev_b32 v98, 1, v83
    ds_read_b128 v[92:95], v98 offset:13232
    ds_read_b64 v[96:97], v83 offset:23232
    s_mov_b64 exec, s[56:57]
    v_and_b32 v112, 0xffff0000, v86
    v_mul_f32 v112, 0.15915494, v112
    v_fract_f32 v112, v112
    v_cos_f32 v112, v112
    s_nop 0
    v_add_f32 v114, v112, v112
    v_fma_f32 v113, v114, v112, -1.0
    v_fma_f32 v114, v114, v113, -v112
    v_cvt_pk_bf16_f32 v115, v112, v113
    v_cvt_pk_bf16_f32 v114, 0, v114
    s_waitcnt lgkmcnt(2)
    s_waitcnt lgkmcnt(0)
    v_dot2_f32_bf16 v92, v92, v115, 0
    v_dot2_f32_bf16 v93, v93, v115, 0
    v_dot2_f32_bf16 v94, v94, v115, 0
    v_dot2_f32_bf16 v95, v95, v115, 0
    v_lshlrev_b32 v112, 16, v96
    v_and_b32 v96, 0xffff0000, v96
    v_lshlrev_b32 v113, 16, v97
    v_and_b32 v97, 0xffff0000, v97
    v_fmac_f32 v92, v112, v114
    v_fmac_f32 v93, v96, v114
    v_fmac_f32 v94, v113, v114
    v_fmac_f32 v95, v97, v114
    s_waitcnt vmcnt(0)
    s_mov_b64 exec, -1
    v_mfma_f32_4x4x4_16b_bf16 v[108:111], v[122:123], v[40:41], 0
    s_mov_b64 exec, s[56:57]
    v_min_u32 v99, 25, v54
    v_cmp_le_u32 vcc, 25, v54
    v_mad_u32_u24 v99, v99, s89, v83
    s_nop 0
    v_mul_f32 v108, v108, v92
    v_mul_f32 v109, v109, v93
    v_mul_f32 v110, v110, v94
    v_mul_f32 v111, v111, v95
    v_cvt_pk_bf16_f32 v40, v108, v109
    v_cvt_pk_bf16_f32 v41, v110, v111
    ds_write_b64 v99, v[40:41] offset:30288
    s_cbranch_vccz gather_scatter__molecular_angular_gemnet__graph_kernel_noovfZ8z
    s_mov_b64 exec, vcc
    v_lshlrev_b32 v98, 1, v83
    ds_add_f32 v98, v108 offset:3232
    ds_add_f32 v98, v109 offset:3236
    ds_add_f32 v98, v110 offset:3240
    ds_add_f32 v98, v111 offset:3244
    s_waitcnt lgkmcnt(0)
gather_scatter__molecular_angular_gemnet__graph_kernel_noovfZ8z:
    s_mov_b64 exec, -1
    v_cmp_lt_i32_e64 s[58:59], 32, v125
    s_mov_b64 exec, s[58:59]
    v_lshrrev_b32 v42, 10, v84
    v_and_b32 v84, 0x3ff, v84
    buffer_load_dwordx2 v[42:43], v42, s[8:11], 0 offen
    v_lshlrev_b32 v84, 3, v84
    s_mov_b64 exec, s[58:59]
    v_lshrrev_b32 v117, 1, v84
    ds_add_rtn_u32 v55, v117, v4 offset:0
    s_mov_b64 exec, s[58:59]
    v_lshlrev_b32 v106, 1, v84
    ds_read_b128 v[100:103], v106 offset:13232
    ds_read_b64 v[104:105], v84 offset:23232
    s_mov_b64 exec, s[58:59]
    v_lshlrev_b32 v112, 16, v87
    v_mul_f32 v112, 0.15915494, v112
    v_fract_f32 v112, v112
    v_cos_f32 v112, v112
    s_nop 0
    v_add_f32 v114, v112, v112
    v_fma_f32 v113, v114, v112, -1.0
    v_fma_f32 v114, v114, v113, -v112
    v_cvt_pk_bf16_f32 v115, v112, v113
    v_cvt_pk_bf16_f32 v114, 0, v114
    s_waitcnt lgkmcnt(2)
    s_waitcnt lgkmcnt(0)
    v_dot2_f32_bf16 v100, v100, v115, 0
    v_dot2_f32_bf16 v101, v101, v115, 0
    v_dot2_f32_bf16 v102, v102, v115, 0
    v_dot2_f32_bf16 v103, v103, v115, 0
    v_lshlrev_b32 v112, 16, v104
    v_and_b32 v104, 0xffff0000, v104
    v_lshlrev_b32 v113, 16, v105
    v_and_b32 v105, 0xffff0000, v105
    v_fmac_f32 v100, v112, v114
    v_fmac_f32 v101, v104, v114
    v_fmac_f32 v102, v113, v114
    v_fmac_f32 v103, v105, v114
    s_waitcnt vmcnt(0)
    s_mov_b64 exec, -1
    v_mfma_f32_4x4x4_16b_bf16 v[108:111], v[122:123], v[42:43], 0
    s_mov_b64 exec, s[58:59]
    v_min_u32 v107, 25, v55
    v_cmp_le_u32 vcc, 25, v55
    v_mad_u32_u24 v107, v107, s89, v84
    s_nop 0
    v_mul_f32 v108, v108, v100
    v_mul_f32 v109, v109, v101
    v_mul_f32 v110, v110, v102
    v_mul_f32 v111, v111, v103
    v_cvt_pk_bf16_f32 v42, v108, v109
    v_cvt_pk_bf16_f32 v43, v110, v111
    ds_write_b64 v107, v[42:43] offset:30288
    s_cbranch_vccz gather_scatter__molecular_angular_gemnet__graph_kernel_noovfZ9z
    s_mov_b64 exec, vcc
    v_lshlrev_b32 v106, 1, v84
    ds_add_f32 v106, v108 offset:3232
    ds_add_f32 v106, v109 offset:3236
    ds_add_f32 v106, v110 offset:3240
    ds_add_f32 v106, v111 offset:3244
    s_waitcnt lgkmcnt(0)
gather_scatter__molecular_angular_gemnet__graph_kernel_noovfZ9z:
    s_mov_b64 exec, -1
    s_mov_b32 s38, 0x0f0f0f0f
    s_mov_b32 s39, 0x0f0f0f0f
    v_cndmask_b32_e64 v108, v127, v126, s[38:39]
    s_nop 1
    v_mov_b32_dpp v109, v108 quad_perm:[0,0,2,2] row_mask:0xf bank_mask:0xf
    v_mov_b32_dpp v15, v108 quad_perm:[1,1,3,3] row_mask:0xf bank_mask:0xf
    v_cmp_eq_u32 vcc, 0, v18
    v_add_u32 v17, v109, v17
    v_subrev_u32 v15, 40, v15
    v_max_i32 v15, 0, v15
    v_cndmask_b32 v16, 0, v15, vcc
    s_nop 1
    v_add_u32_dpp v16, v16, v16 row_shr:1 row_mask:0xf bank_mask:0xf bound_ctrl:0
    s_nop 1
    v_add_u32_dpp v16, v16, v16 row_shr:2 row_mask:0xf bank_mask:0xf bound_ctrl:0
    s_nop 1
    v_add_u32_dpp v16, v16, v16 row_shr:4 row_mask:0xf bank_mask:0xf bound_ctrl:0
    s_nop 1
    v_add_u32_dpp v16, v16, v16 row_shr:8 row_mask:0xf bank_mask:0xf bound_ctrl:0
    s_nop 1
    v_add_u32_dpp v16, v16, v16 row_bcast:15 row_mask:0xa bank_mask:0xf
    s_nop 1
    v_add_u32_dpp v16, v16, v16 row_bcast:31 row_mask:0xc bank_mask:0xf
    s_nop 0
    v_readlane_b32 s35, v16, 63
    v_sub_u32 v16, v16, v15
    v_sub_u32 v17, v17, v16
    s_add_u32 s37, s34, 128
    v_sub_u32 v108, s34, v16
    v_sub_u32 v109, s37, v16
    v_max_i32 v108, 0, v108
    v_min_i32 v109, v109, v15
    v_add_u32 v108, v108, v18
    v_add_u32 v110, v108, v16
    v_subrev_u32 v110, s34, v110
    v_lshl_add_u32 v110, s32, 7, v110
    s_sub_u32 s36, s35, s34
    s_min_i32 s36, s36, 128
gather_scatter__molecular_angular_gemnet__graph_kernel_lloopz:
    v_cmpx_lt_i32 vcc, v108, v109
    s_cbranch_execz gather_scatter__molecular_angular_gemnet__graph_kernel_ldonez
    ds_write_b8 v110, v19 offset:28240
    v_add_u32 v108, 4, v108
    v_add_u32 v110, 4, v110
    s_branch gather_scatter__molecular_angular_gemnet__graph_kernel_lloopz
gather_scatter__molecular_angular_gemnet__graph_kernel_ldonez:
    s_mov_b64 exec, -1
    ds_read_u8 v88, v14 offset:28240
    ds_read_u8 v90, v14 offset:28304
    s_sub_i32 s37, s36, 0
    v_cmp_gt_i32_e64 s[64:65], s37, v1
    s_sub_i32 s37, s36, 64
    v_cmp_gt_i32_e64 s[66:67], s37, v1
    v_add_u32 v111, s34, v1
    s_waitcnt lgkmcnt(0)
    ds_bpermute_b32 v88, v88, v17
    ds_bpermute_b32 v90, v90, v17
    s_waitcnt lgkmcnt(0)
    v_add_lshl_u32 v88, v88, v111, 3
    v_add_lshl_u32 v90, v90, v111, 3
    s_mov_b64 exec, s[64:65]
    buffer_load_dwordx2 v[88:89], v88, s[4:7], s88 offen offset:0
    s_mov_b64 exec, s[66:67]
    buffer_load_dwordx2 v[90:91], v90, s[4:7], s88 offen offset:512
    s_mov_b64 exec, -1
    s_add_u32 s37, s34, 128
    s_cmp_gt_u32 s35, s37
    s_cbranch_scc0 gather_scatter__molecular_angular_gemnet__graph_kernel_nomorez
    v_mov_b32 v112, 2560
    v_mov_b32 v113, s37
    ds_write_b32 v112, v113
gather_scatter__molecular_angular_gemnet__graph_kernel_nomorez:
    s_waitcnt vmcnt(1)
    s_mov_b64 exec, s[64:65]
    v_lshrrev_b32 v48, 10, v88
    v_and_b32 v88, 0x3ff, v88
    buffer_load_dwordx2 v[48:49], v48, s[8:11], 0 offen
    v_lshlrev_b32 v88, 3, v88
    s_mov_b64 exec, s[64:65]
    v_lshrrev_b32 v116, 1, v88
    ds_add_rtn_u32 v54, v116, v4 offset:0
    s_mov_b64 exec, s[64:65]
    v_lshlrev_b32 v98, 1, v88
    ds_read_b128 v[92:95], v98 offset:13232
    ds_read_b64 v[96:97], v88 offset:23232
    s_mov_b64 exec, s[64:65]
    v_lshlrev_b32 v112, 16, v89
    v_mul_f32 v112, 0.15915494, v112
    v_fract_f32 v112, v112
    v_cos_f32 v112, v112
    s_nop 0
    v_add_f32 v114, v112, v112
    v_fma_f32 v113, v114, v112, -1.0
    v_fma_f32 v114, v114, v113, -v112
    v_cvt_pk_bf16_f32 v115, v112, v113
    v_cvt_pk_bf16_f32 v114, 0, v114
    s_waitcnt lgkmcnt(2)
    s_waitcnt lgkmcnt(0)
    v_dot2_f32_bf16 v92, v92, v115, 0
    v_dot2_f32_bf16 v93, v93, v115, 0
    v_dot2_f32_bf16 v94, v94, v115, 0
    v_dot2_f32_bf16 v95, v95, v115, 0
    v_lshlrev_b32 v112, 16, v96
    v_and_b32 v96, 0xffff0000, v96
    v_lshlrev_b32 v113, 16, v97
    v_and_b32 v97, 0xffff0000, v97
    v_fmac_f32 v92, v112, v114
    v_fmac_f32 v93, v96, v114
    v_fmac_f32 v94, v113, v114
    v_fmac_f32 v95, v97, v114
    s_waitcnt vmcnt(0)
    s_mov_b64 exec, -1
    v_mfma_f32_4x4x4_16b_bf16 v[108:111], v[122:123], v[48:49], 0
    s_mov_b64 exec, s[64:65]
    v_min_u32 v99, 25, v54
    v_cmp_le_u32 vcc, 25, v54
    v_mad_u32_u24 v99, v99, s89, v88
    s_nop 0
    v_mul_f32 v108, v108, v92
    v_mul_f32 v109, v109, v93
    v_mul_f32 v110, v110, v94
    v_mul_f32 v111, v111, v95
    v_cvt_pk_bf16_f32 v48, v108, v109
    v_cvt_pk_bf16_f32 v49, v110, v111
    ds_write_b64 v99, v[48:49] offset:30288
    s_cbranch_vccz gather_scatter__molecular_angular_gemnet__graph_kernel_noovfT0z
    s_mov_b64 exec, vcc
    v_lshlrev_b32 v98, 1, v88
    ds_add_f32 v98, v108 offset:3232
    ds_add_f32 v98, v109 offset:3236
    ds_add_f32 v98, v110 offset:3240
    ds_add_f32 v98, v111 offset:3244
    s_waitcnt lgkmcnt(0)
gather_scatter__molecular_angular_gemnet__graph_kernel_noovfT0z:
    s_mov_b64 exec, s[66:67]
    v_lshrrev_b32 v50, 10, v90
    v_and_b32 v90, 0x3ff, v90
    buffer_load_dwordx2 v[50:51], v50, s[8:11], 0 offen
    v_lshlrev_b32 v90, 3, v90
    s_mov_b64 exec, s[66:67]
    v_lshrrev_b32 v117, 1, v90
    ds_add_rtn_u32 v23, v117, v4 offset:0
    s_mov_b64 exec, s[66:67]
    v_lshlrev_b32 v106, 1, v90
    ds_read_b128 v[100:103], v106 offset:13232
    ds_read_b64 v[104:105], v90 offset:23232
    s_mov_b64 exec, s[66:67]
    v_lshlrev_b32 v112, 16, v91
    v_mul_f32 v112, 0.15915494, v112
    v_fract_f32 v112, v112
    v_cos_f32 v112, v112
    s_nop 0
    v_add_f32 v114, v112, v112
    v_fma_f32 v113, v114, v112, -1.0
    v_fma_f32 v114, v114, v113, -v112
    v_cvt_pk_bf16_f32 v115, v112, v113
    v_cvt_pk_bf16_f32 v114, 0, v114
    s_waitcnt lgkmcnt(2)
    s_waitcnt lgkmcnt(0)
    v_dot2_f32_bf16 v100, v100, v115, 0
    v_dot2_f32_bf16 v101, v101, v115, 0
    v_dot2_f32_bf16 v102, v102, v115, 0
    v_dot2_f32_bf16 v103, v103, v115, 0
    v_lshlrev_b32 v112, 16, v104
    v_and_b32 v104, 0xffff0000, v104
    v_lshlrev_b32 v113, 16, v105
    v_and_b32 v105, 0xffff0000, v105
    v_fmac_f32 v100, v112, v114
    v_fmac_f32 v101, v104, v114
    v_fmac_f32 v102, v113, v114
    v_fmac_f32 v103, v105, v114
    s_waitcnt vmcnt(0)
    s_mov_b64 exec, -1
    v_mfma_f32_4x4x4_16b_bf16 v[108:111], v[122:123], v[50:51], 0
    s_mov_b64 exec, s[66:67]
    v_min_u32 v107, 25, v23
    v_cmp_le_u32 vcc, 25, v23
    v_mad_u32_u24 v107, v107, s89, v90
    s_nop 0
    v_mul_f32 v108, v108, v100
    v_mul_f32 v109, v109, v101
    v_mul_f32 v110, v110, v102
    v_mul_f32 v111, v111, v103
    v_cvt_pk_bf16_f32 v50, v108, v109
    v_cvt_pk_bf16_f32 v51, v110, v111
    ds_write_b64 v107, v[50:51] offset:30288
    s_cbranch_vccz gather_scatter__molecular_angular_gemnet__graph_kernel_noovfT1z
    s_mov_b64 exec, vcc
    v_lshlrev_b32 v106, 1, v90
    ds_add_f32 v106, v108 offset:3232
    ds_add_f32 v106, v109 offset:3236
    ds_add_f32 v106, v110 offset:3240
    ds_add_f32 v106, v111 offset:3244
    s_waitcnt lgkmcnt(0)
gather_scatter__molecular_angular_gemnet__graph_kernel_noovfT1z:
    s_branch gather_scatter__molecular_angular_gemnet__graph_kernel_sdone
.section .rodata,"a"
.p2align 6
.amdhsa_kernel gs_bin_kernel
  .amdhsa_next_free_vgpr 108
  .amdhsa_next_free_sgpr 102
  .amdhsa_accum_offset 108
  .amdhsa_group_segment_fixed_size 0
  .amdhsa_kernarg_size 112
  .amdhsa_user_sgpr_count 2
  .amdhsa_user_sgpr_kernarg_segment_ptr 1
  .amdhsa_system_sgpr_workgroup_id_x 1
.end_amdhsa_kernel
.p2align 6
.amdhsa_kernel gather_scatter__molecular_angular_gemnet__graph_kernel
  .amdhsa_next_free_vgpr 128
  .amdhsa_next_free_sgpr 102
  .amdhsa_accum_offset 128
  .amdhsa_group_segment_fixed_size 0
  .amdhsa_kernarg_size 112
  .amdhsa_user_sgpr_count 2
  .amdhsa_user_sgpr_kernarg_segment_ptr 1
  .amdhsa_system_sgpr_workgroup_id_x 1
.end_amdhsa_kernel
```
